```python
import torch

def _softmax(x, axis=-1):
    return torch.softmax(x, dim=axis)
def _gelu(x):
    return torch.nn.functional.gelu(x, approximate="tanh")
def _silu(x):
    return torch.nn.functional.silu(x)
def _sigmoid(x):
    return torch.sigmoid(x)
def _layernorm(x, axis=-1, eps=1e-5):
    m = x.mean(dim=axis, keepdim=True)
    v = x.var(dim=axis, keepdim=True, unbiased=False)
    return (x - m) / torch.sqrt(v + eps)
def _scatter_add(tgt, idx, src, axis=0):
    return tgt.clone().index_add_(axis, idx, src)
def _segment_sum(src, seg, n):
    out = torch.zeros((n,) + src.shape[1:], dtype=src.dtype)
    return out.index_add_(0, seg, src)
def _pad(x, pw):
    flat = tuple(v for pair in reversed(pw) for v in pair)
    return torch.nn.functional.pad(x, flat)

kernel_name = 'gated_mix__mha_block__mixer_token_mlp__prompt'

def setup_inputs():

    _w = (lambda a: (lambda t: t.to(torch.bfloat16) if t.is_floating_point() else t)(torch.as_tensor(a)))
    def _A_setup():
        B, S, D, H = 1, 2048, 512, 32
        return {
            "x": _w((lambda *s: torch.randn(*s, dtype=torch.bfloat16) * 0.05)(B, S, D)),
            "wqkv": _w((lambda *s: torch.randn(*s, dtype=torch.bfloat16) * 0.8)(D, 3 * D)),
            "wo": _w((lambda *s: torch.randn(*s, dtype=torch.bfloat16) * 0.05)(D, D)),
        }
    _A_in = _A_setup()

    def _B_setup():
        B, S, D, F = 1, 2048, 512, 1792
        return {
            "x": _w((lambda *s: torch.randn(*s, dtype=torch.bfloat16) * 0.05)(B, S, D)),
            "w1": _w((lambda *s: torch.randn(*s, dtype=torch.bfloat16) * 0.8)(S, F) * (S ** -0.5)),
            "b1": _w((lambda *s: torch.randn(*s, dtype=torch.bfloat16) * 12.8)(F) * 0.02),
            "w2": _w((lambda *s: torch.randn(*s, dtype=torch.bfloat16) * 0.05)(F, S) * (F ** -0.5)),
            "b2": _w((lambda *s: torch.randn(*s, dtype=torch.bfloat16) * 0.8)(S) * 0.02),
        }
    _B_in = _B_setup()

    return {
        "A_x": _A_in["x"],
        "A_wqkv": _A_in["wqkv"],
        "A_wo": _A_in["wo"],
        "B_x": _B_in["x"],
        "B_w1": _B_in["w1"],
        "B_b1": _B_in["b1"],
        "B_w2": _B_in["w2"],
        "B_b2": _B_in["b2"],
        "gate_w": _w((lambda *s: torch.randn(*s, dtype=torch.bfloat16) * 0.05)(512) * 16.0),
    }

def reference(A_x, A_wqkv, A_wo, B_x, B_w1, B_b1, B_w2, B_b2, gate_w):
    def _A_ref(x, wqkv, wo):
        B, S, D = x.shape
        H = 32
        Dh = D // H
        qkv = (lambda x, *d: x.permute(*d))((x @ wqkv).reshape(B, S, 3, H, Dh), 2, 0, 3, 1, 4)
        q, k, v = qkv[0], qkv[1], qkv[2]
        scores = torch.einsum("bhqd,bhkd->bhqk", q, k) * (Dh ** -0.5)
        p = _softmax(scores, axis=-1)
        o = torch.einsum("bhqk,bhkd->bhqd", p, v)
        return (lambda x, *d: x.permute(*d))(o, 0, 2, 1, 3).reshape(B, S, D) @ wo

    def _B_ref(x, w1, b1, w2, b2):
        B, S, D = x.shape
        h = _layernorm(x, axis=-1)
        u = torch.einsum("bsd,sf->bdf", h, w1) + b1
        u = _gelu(u)
        y = torch.einsum("bdf,fs->bds", u, w2) + b2
        return (lambda x, *d: x.permute(*d))(y, 0, 2, 1)

    x = A_x
    g = _sigmoid((x * gate_w).sum(-1, keepdims=True))
    a = _A_ref(x, A_wqkv, A_wo)
    b = _B_ref(x, B_w1, B_b1, B_w2, B_b2)
    return g * a + (1 - g) * b
```

```asm
; @launch grid=(256,1,1) block=(512,1,1) lds=163840
.amdgcn_target "amdgcn-amd-amdhsa--gfx950"
.text
.globl gated_mix__mha_block__mixer_token_mlp__prompt_kernel
.p2align 8
.type gated_mix__mha_block__mixer_token_mlp__prompt_kernel,@function
gated_mix__mha_block__mixer_token_mlp__prompt_kernel:
    s_cmp_ge_u32 s2, 256
    s_cbranch_scc1 L_exit
    s_load_dwordx16 s[16:31], s[0:1], 0
    s_load_dwordx8 s[32:39], s[0:1], 64
    s_memrealtime s[12:13]
    v_lshrrev_b32 v1, 6, v0
    v_and_b32 v0, 63, v0
    v_readfirstlane_b32 s3, v1
    s_and_b32 s4, s2, 7
    s_lshr_b32 s5, s2, 3
    s_and_b32 s9, s5, 1
    s_lshl_b32 s8, s4, 1
    s_add_u32 s6, s8, s9
    s_lshr_b32 s7, s5, 1
    s_mul_i32 s9, s9, 0
    s_add_u32 s85, s9, s7
    s_add_u32 s85, s85, s4
    s_and_b32 s81, s3, 3
    v_lshlrev_b32 v1, 4, v0
    s_cmp_lt_u32 s3, 6
    s_cbranch_scc1 L_nocpf_1
    s_getpc_b64 s[88:89]
L_pc0:
    s_mov_b32 s90, L_code_end-L_pc0
    s_mov_b32 s91, 0x00020000
    s_and_b32 s8, s3, 1
    s_lshl_b32 s8, s8, 5
    s_add_u32 s8, s8, s5
    s_lshl_b32 s8, s8, 10
    buffer_load_dwordx4 v[248:251], v1, s[88:91], s8 offen
L_nocpf_1:
    s_cmp_ge_u32 s3, 4
    s_cbranch_scc1 L_eb_2
    v_lshrrev_b32 v41, 3, v0
    v_lshlrev_b32 v41, 10, v41
    v_and_b32 v42, 7, v0
    v_lshrrev_b32 v43, 4, v0
    v_xor_b32 v42, v42, v43
    v_lshl_add_u32 v166, v42, 4, v41
    v_xor_b32 v42, 4, v42
    v_lshl_add_u32 v167, v42, 4, v41
    v_add_u32 v168, 14336, v166
    v_add_u32 v169, 21504, v167
    v_add_u32 v167, 7168, v167
    s_lshl_b32 s82, s7, 17
    s_lshl_b32 s8, s81, 15
    s_add_u32 s82, s82, s8
    s_lshl_b32 s83, s81, 12
    s_mov_b32 s86, 128
    s_mov_b32 s87, 16384
    s_waitcnt lgkmcnt(0)
    s_mov_b32 s44, s16
    s_mov_b32 s45, s17
    s_mov_b32 s46, 0x200000
    s_mov_b32 s47, 0x00020000
    s_branch L_ej_3
L_eb_2:
    v_lshrrev_b32 v41, 2, v0
    v_mul_u32_u24 v41, 3072, v41
    v_and_b32 v42, 3, v0
    v_lshl_add_u32 v166, v42, 4, v41
    v_mov_b32 v167, v166
    v_mov_b32 v168, v166
    v_mov_b32 v169, v166
    s_mul_i32 s82, s81, 49152
    s_lshl_b32 s8, s6, 6
    s_add_u32 s82, s82, s8
    s_mul_i32 s83, s81, 3072
    s_add_u32 s83, s83, 65536
    s_mov_b32 s86, 196608
    s_mov_b32 s87, 12288
    s_waitcnt lgkmcnt(0)
    s_mov_b32 s44, s18
    s_mov_b32 s45, s19
    s_mov_b32 s46, 0x180000
    s_mov_b32 s47, 0x00020000
L_ej_3:
    s_and_b32 s8, s85, 7
    s_add_u32 s85, s85, 1
    s_mul_i32 s8, s8, s86
    s_mul_i32 s9, s87, 0
    s_add_u32 m0, s83, s9
    s_add_u32 s8, s8, s82
    buffer_load_dwordx4 v166, s[44:47], s8 offen offset:0 lds
    buffer_load_dwordx4 v167, s[44:47], s8 offen offset:1024 lds
    buffer_load_dwordx4 v168, s[44:47], s8 offen offset:2048 lds
    s_cmp_ge_u32 s3, 4
    s_cbranch_scc1 L_no4_4
    buffer_load_dwordx4 v169, s[44:47], s8 offen offset:3072 lds
L_no4_4:
    s_and_b32 s8, s85, 7
    s_add_u32 s85, s85, 1
    s_mul_i32 s8, s8, s86
    s_mul_i32 s9, s87, 1
    s_add_u32 m0, s83, s9
    s_add_u32 s8, s8, s82
    buffer_load_dwordx4 v166, s[44:47], s8 offen offset:0 lds
    buffer_load_dwordx4 v167, s[44:47], s8 offen offset:1024 lds
    buffer_load_dwordx4 v168, s[44:47], s8 offen offset:2048 lds
    s_cmp_ge_u32 s3, 4
    s_cbranch_scc1 L_no4_5
    buffer_load_dwordx4 v169, s[44:47], s8 offen offset:3072 lds
L_no4_5:
    s_mov_b32 s40, s16
    s_mov_b32 s41, s17
    s_mov_b32 s42, 0x200000
    s_mov_b32 s43, 0x00020000
    s_mov_b32 s76, s32
    s_mov_b32 s77, s33
    s_mov_b32 s78, 0x400
    s_mov_b32 s79, 0x00020000
    s_lshl_b32 s8, s7, 7
    s_lshl_b32 s9, s6, 3
    s_add_u32 s80, s8, s9
    s_mov_b32 s92, s36
    s_mov_b32 s93, s37
    s_mov_b32 s94, 0x100
    s_mov_b32 s95, 0x00020000
    s_mov_b32 s60, s38
    s_mov_b32 s61, s39
    s_mov_b32 s62, 0x1200000
    s_mov_b32 s63, 0x00020000
    s_or_b32 s8, s2, s3
    s_cmp_lg_u32 s8, 0
    s_cbranch_scc1 L_notag_6
    s_or_b32 s8, s12, 1
    v_mov_b32 v44, s8
    v_mov_b32 v45, s13
    v_mov_b32 v46, 0
    s_mov_b64 exec, 1
    buffer_store_dwordx2 v[44:45], v46, s[92:95], 0 offen sc1
    s_mov_b64 exec, -1
L_notag_6:
    v_and_b32 v41, 31, v0
    v_lshrrev_b32 v42, 5, v0
    v_bfe_u32 v43, v0, 1, 3
    v_xor_b32 v44, v42, v43
    v_lshlrev_b32 v45, 7, v41
    s_lshl_b32 s8, s81, 12
    v_add_u32 v45, s8, v45
    v_lshl_add_u32 v160, v44, 4, v45
    v_xor_b32 v161, 32, v160
    v_xor_b32 v162, 64, v160
    v_xor_b32 v163, 96, v160
    v_lshlrev_b32 v44, 9, v42
    v_bfe_u32 v45, v0, 2, 2
    v_lshl_add_u32 v44, v45, 6, v44
    v_bfe_u32 v45, v0, 4, 1
    v_lshl_add_u32 v44, v45, 5, v44
    v_and_b32 v45, 3, v0
    v_lshl_add_u32 v44, v45, 3, v44
    v_add_u32 v164, 65536, v44
    v_lshlrev_b32 v41, 2, v0
    v_add_u32 v41, 156416, v41
    v_mov_b32 v42, 0
    ds_write_b32 v41, v42
    s_add_u32 s8, s80, s3
    s_lshl_b32 s8, s8, 10
    buffer_load_dwordx4 v[176:179], v1, s[40:43], s8 offen
    buffer_load_dwordx4 v[180:183], v1, s[76:79], 0 offen
    s_cmp_ge_u32 s3, 4
    s_cbranch_scc1 L_roleb
    s_waitcnt vmcnt(6)
    s_barrier
    ds_read_b128 v[112:115], v160 offset:0
    ds_read_b64_tr_b16 v[128:129], v164 offset:0
    ds_read_b64_tr_b16 v[130:131], v164 offset:256
    ds_read_b128 v[116:119], v161 offset:0
    ds_read_b64_tr_b16 v[136:137], v164 offset:3072
    ds_read_b64_tr_b16 v[138:139], v164 offset:3328
    ds_read_b128 v[120:123], v162 offset:0
    ds_read_b64_tr_b16 v[144:145], v164 offset:6144
    ds_read_b64_tr_b16 v[146:147], v164 offset:6400
    ds_read_b128 v[124:127], v163 offset:0
    ds_read_b64_tr_b16 v[152:153], v164 offset:9216
    ds_read_b64_tr_b16 v[154:155], v164 offset:9472
    s_and_b32 s8, s85, 7
    s_add_u32 s85, s85, 1
    s_mul_i32 s8, s8, s86
    s_add_u32 m0, s83, 32768
    s_add_u32 s8, s8, s82
    buffer_load_dwordx4 v166, s[44:47], s8 offen offset:0 lds
    buffer_load_dwordx4 v167, s[44:47], s8 offen offset:1024 lds
    buffer_load_dwordx4 v168, s[44:47], s8 offen offset:2048 lds
    buffer_load_dwordx4 v169, s[44:47], s8 offen offset:3072 lds
    s_waitcnt lgkmcnt(0)
    v_mfma_f32_32x32x16_bf16 v[96:111], v[128:131], v[112:115], 0
    s_waitcnt vmcnt(6)
    s_barrier
    ds_read_b128 v[16:19], v160 offset:16384
    ds_read_b64_tr_b16 v[32:33], v164 offset:12288
    ds_read_b64_tr_b16 v[34:35], v164 offset:12544
    ds_read_b128 v[20:23], v161 offset:16384
    v_mfma_f32_32x32x16_bf16 v[96:111], v[136:139], v[116:119], v[96:111]
    ds_read_b64_tr_b16 v[40:41], v164 offset:15360
    ds_read_b64_tr_b16 v[42:43], v164 offset:15616
    ds_read_b128 v[24:27], v162 offset:16384
    ds_read_b64_tr_b16 v[48:49], v164 offset:18432
    v_mfma_f32_32x32x16_bf16 v[96:111], v[144:147], v[120:123], v[96:111]
    ds_read_b64_tr_b16 v[50:51], v164 offset:18688
    ds_read_b128 v[28:31], v163 offset:16384
    ds_read_b64_tr_b16 v[56:57], v164 offset:21504
    ds_read_b64_tr_b16 v[58:59], v164 offset:21760
    v_mfma_f32_32x32x16_bf16 v[96:111], v[152:155], v[124:127], v[96:111]
    s_and_b32 s8, s85, 7
    s_add_u32 s85, s85, 1
    s_mul_i32 s8, s8, s86
    s_add_u32 m0, s83, 49152
    s_add_u32 s8, s8, s82
    buffer_load_dwordx4 v166, s[44:47], s8 offen offset:0 lds
    buffer_load_dwordx4 v167, s[44:47], s8 offen offset:1024 lds
    buffer_load_dwordx4 v168, s[44:47], s8 offen offset:2048 lds
    buffer_load_dwordx4 v169, s[44:47], s8 offen offset:3072 lds
    s_waitcnt vmcnt(8)
    v_lshlrev_b32 v184, 16, v176
    v_and_b32 v185, 0xffff0000, v176
    v_lshlrev_b32 v192, 16, v180
    v_and_b32 v193, 0xffff0000, v180
    v_lshlrev_b32 v186, 16, v177
    v_and_b32 v187, 0xffff0000, v177
    v_lshlrev_b32 v194, 16, v181
    v_and_b32 v195, 0xffff0000, v181
    v_lshlrev_b32 v188, 16, v178
    v_and_b32 v189, 0xffff0000, v178
    v_lshlrev_b32 v196, 16, v182
    v_and_b32 v197, 0xffff0000, v182
    v_lshlrev_b32 v190, 16, v179
    v_and_b32 v191, 0xffff0000, v179
    v_lshlrev_b32 v198, 16, v183
    v_and_b32 v199, 0xffff0000, v183
    v_add_f32 v200, v184, v185
    v_mul_f32 v201, v184, v192
    v_fmac_f32 v201, v185, v193
    v_add_f32 v200, v200, v186
    v_fmac_f32 v201, v186, v194
    v_add_f32 v200, v200, v187
    v_fmac_f32 v201, v187, v195
    v_add_f32 v200, v200, v188
    v_fmac_f32 v201, v188, v196
    v_add_f32 v200, v200, v189
    v_fmac_f32 v201, v189, v197
    v_add_f32 v200, v200, v190
    v_fmac_f32 v201, v190, v198
    v_add_f32 v200, v200, v191
    v_fmac_f32 v201, v191, v199
    s_nop 0
    s_nop 0
    v_add_f32_dpp v200, v200, v200 row_shr:1 row_mask:0xf bank_mask:0xf bound_ctrl:0
    v_add_f32_dpp v201, v201, v201 row_shr:1 row_mask:0xf bank_mask:0xf bound_ctrl:0
    s_nop 0
    v_add_f32_dpp v200, v200, v200 row_shr:2 row_mask:0xf bank_mask:0xf bound_ctrl:0
    v_add_f32_dpp v201, v201, v201 row_shr:2 row_mask:0xf bank_mask:0xf bound_ctrl:0
    s_nop 0
    v_add_f32_dpp v200, v200, v200 row_shr:4 row_mask:0xf bank_mask:0xf bound_ctrl:0
    v_add_f32_dpp v201, v201, v201 row_shr:4 row_mask:0xf bank_mask:0xf bound_ctrl:0
    s_nop 0
    v_add_f32_dpp v200, v200, v200 row_shr:8 row_mask:0xf bank_mask:0xf bound_ctrl:0
    v_add_f32_dpp v201, v201, v201 row_shr:8 row_mask:0xf bank_mask:0xf bound_ctrl:0
    s_nop 0
    v_add_f32_dpp v200, v200, v200 row_bcast:15 row_mask:0xa bank_mask:0xf
    v_add_f32_dpp v201, v201, v201 row_bcast:15 row_mask:0xa bank_mask:0xf
    s_nop 0
    v_add_f32_dpp v200, v200, v200 row_bcast:31 row_mask:0xc bank_mask:0xf
    v_add_f32_dpp v201, v201, v201 row_bcast:31 row_mask:0xc bank_mask:0xf
    s_nop 1
    v_readlane_b32 s8, v200, 63
    v_readlane_b32 s9, v201, 63
    v_mov_b32 v202, 0x3b000000
    v_mov_b32 v214, 0xbfb8aa3b
    v_mul_f32 v202, s8, v202
    v_mul_f32 v214, s9, v214
    v_sub_f32 v184, v184, v202
    v_sub_f32 v185, v185, v202
    v_sub_f32 v186, v186, v202
    v_sub_f32 v187, v187, v202
    v_sub_f32 v188, v188, v202
    v_sub_f32 v189, v189, v202
    v_sub_f32 v190, v190, v202
    v_sub_f32 v191, v191, v202
    v_exp_f32 v214, v214
    v_mul_f32 v200, v184, v184
    v_fmac_f32 v200, v185, v185
    v_fmac_f32 v200, v186, v186
    v_fmac_f32 v200, v187, v187
    v_fmac_f32 v200, v188, v188
    v_fmac_f32 v200, v189, v189
    v_fmac_f32 v200, v190, v190
    v_fmac_f32 v200, v191, v191
    s_nop 1
    v_add_f32_dpp v200, v200, v200 row_shr:1 row_mask:0xf bank_mask:0xf bound_ctrl:0
    s_nop 1
    v_add_f32_dpp v200, v200, v200 row_shr:2 row_mask:0xf bank_mask:0xf bound_ctrl:0
    s_nop 1
    v_add_f32_dpp v200, v200, v200 row_shr:4 row_mask:0xf bank_mask:0xf bound_ctrl:0
    s_nop 1
    v_add_f32_dpp v200, v200, v200 row_shr:8 row_mask:0xf bank_mask:0xf bound_ctrl:0
    s_nop 1
    v_add_f32_dpp v200, v200, v200 row_bcast:15 row_mask:0xa bank_mask:0xf
    s_nop 1
    v_add_f32_dpp v200, v200, v200 row_bcast:31 row_mask:0xc bank_mask:0xf
    s_nop 1
    v_readlane_b32 s8, v200, 63
    v_add_f32 v214, 1.0, v214
    v_mov_b32 v202, 0x3b000000
    v_mov_b32 v203, 0x3727c5ac
    v_fma_f32 v202, s8, v202, v203
    v_rsq_f32 v202, v202
    v_rcp_f32 v214, v214
    v_mul_f32 v184, v184, v202
    v_mul_f32 v185, v185, v202
    v_mul_f32 v186, v186, v202
    v_mul_f32 v187, v187, v202
    v_mul_f32 v188, v188, v202
    v_mul_f32 v189, v189, v202
    v_mul_f32 v190, v190, v202
    v_mul_f32 v191, v191, v202
    v_cvt_pk_bf16_f32 v192, v184, v185
    v_cvt_pk_bf16_f32 v193, v186, v187
    v_cvt_pk_bf16_f32 v194, v188, v189
    v_cvt_pk_bf16_f32 v195, v190, v191
    v_mul_u32_u24 v204, 144, v0
    s_lshl_b32 s8, s3, 1
    s_add_u32 s8, s8, 114688
    v_add_u32 v204, s8, v204
    ds_write_b16 v204, v192 offset:0
    ds_write_b16_d16_hi v204, v192 offset:16
    ds_write_b16 v204, v193 offset:32
    ds_write_b16_d16_hi v204, v193 offset:48
    ds_write_b16 v204, v194 offset:64
    ds_write_b16_d16_hi v204, v194 offset:80
    ds_write_b16 v204, v195 offset:96
    ds_write_b16_d16_hi v204, v195 offset:112
    v_bfe_u32 v205, v0, 2, 1
    v_bfe_u32 v206, v0, 3, 1
    v_lshrrev_b32 v207, 4, v0
    v_lshl_add_u32 v207, v207, 1, v205
    v_mul_u32_u24 v204, 144, v207
    v_and_b32 v207, 3, v0
    v_lshl_add_u32 v207, v206, 2, v207
    v_lshl_add_u32 v204, v207, 4, v204
    s_mul_i32 s8, s3, 1152
    s_add_u32 s8, s8, 114688
    v_add_u32 v204, s8, v204
    v_lshrrev_b32 v205, 5, v0
    v_lshlrev_b32 v205, 10, v205
    v_and_b32 v210, 31, v0
    v_lshl_add_u32 v205, v210, 4, v205
    s_lshl_b32 s10, s3, 18
    s_lshr_b32 s9, s80, 4
    s_lshl_b32 s9, s9, 11
    s_add_u32 s10, s10, s9
    s_and_b32 s9, s80, 8
    s_lshl_b32 s9, s9, 6
    s_add_u32 s10, s10, s9
    s_add_u32 s11, s80, s3
    s_lshl_b32 s11, s11, 2
    s_add_u32 s11, s11, 12582912
    v_mov_b32 v210, 0
    s_waitcnt lgkmcnt(0)
    v_mfma_f32_32x32x16_bf16 v[96:111], v[32:35], v[16:19], v[96:111]
    s_waitcnt vmcnt(4)
    s_barrier
    ds_read_b128 v[112:115], v160 offset:32768
    ds_read_b64_tr_b16 v[128:129], v164 offset:24576
    ds_read_b64_tr_b16 v[130:131], v164 offset:24832
    ds_read_b128 v[116:119], v161 offset:32768
    v_mfma_f32_32x32x16_bf16 v[96:111], v[40:43], v[20:23], v[96:111]
    ds_read_b64_tr_b16 v[136:137], v164 offset:27648
    ds_read_b64_tr_b16 v[138:139], v164 offset:27904
    ds_read_b128 v[120:123], v162 offset:32768
    ds_read_b64_tr_b16 v[144:145], v164 offset:30720
    v_mfma_f32_32x32x16_bf16 v[96:111], v[48:51], v[24:27], v[96:111]
    ds_read_b64_tr_b16 v[146:147], v164 offset:30976
    ds_read_b128 v[124:127], v163 offset:32768
    ds_read_b64_tr_b16 v[152:153], v164 offset:33792
    ds_read_b64_tr_b16 v[154:155], v164 offset:34048
    v_mfma_f32_32x32x16_bf16 v[96:111], v[56:59], v[28:31], v[96:111]
    ds_read_b128 v[206:209], v204
    s_waitcnt lgkmcnt(0)
    buffer_store_dwordx4 v[206:209], v205, s[60:63], s10 offen sc1
    s_mov_b64 exec, 1
    buffer_store_dword v214, v210, s[60:63], s11 offen sc1
    s_mov_b64 exec, -1
    buffer_load_dwordx2 v[216:217], v210, s[92:95], 0 offen sc1
    s_and_b32 s8, s85, 7
    s_add_u32 s85, s85, 1
    s_mul_i32 s8, s8, s86
    s_add_u32 m0, s83, 0
    s_add_u32 s8, s8, s82
    buffer_load_dwordx4 v166, s[44:47], s8 offen offset:0 lds
    buffer_load_dwordx4 v167, s[44:47], s8 offen offset:1024 lds
    buffer_load_dwordx4 v168, s[44:47], s8 offen offset:2048 lds
    buffer_load_dwordx4 v169, s[44:47], s8 offen offset:3072 lds
    s_mov_b32 s52, s24
    s_mov_b32 s53, s25
    s_mov_b32 s54, 0x700000
    s_mov_b32 s55, 0x00020000
    v_lshrrev_b32 v174, 5, v0
    v_mul_u32_u24 v174, 3584, v174
    v_and_b32 v175, 31, v0
    v_lshl_add_u32 v174, v175, 4, v174
    s_lshr_b32 s8, s4, 1
    s_mul_i32 s8, s8, 7
    s_and_b32 s9, s4, 1
    s_mul_i32 s9, s9, 3
    s_add_u32 s8, s8, s9
    s_lshl_b32 s90, s8, 7
    s_lshl_b32 s8, s5, 3
    s_add_u32 s8, s8, s3
    s_lshr_b32 s9, s8, 6
    s_lshl_b32 s9, s9, 9
    s_and_b32 s8, s8, 63
    s_lshl_b32 s8, s8, 1
    s_add_u32 s8, s8, s9
    s_mul_i32 s8, s8, 3584
    s_add_u32 s8, s8, s90
    s_mov_b32 s87, s8
    s_lshl_b32 s84, s7, 2
    s_add_u32 s84, s84, s81
    v_lshlrev_b32 v170, 4, v0
    s_lshl_b32 s8, s81, 10
    s_add_u32 s8, s8, 148224
    v_add_u32 v171, s8, v170
    s_waitcnt lgkmcnt(0)
    v_mfma_f32_32x32x16_bf16 v[96:111], v[128:131], v[112:115], v[96:111]
    s_waitcnt vmcnt(7)
    s_barrier
    ds_read_b128 v[16:19], v160 offset:49152
    ds_read_b64_tr_b16 v[32:33], v164 offset:36864
    ds_read_b64_tr_b16 v[34:35], v164 offset:37120
    ds_read_b128 v[20:23], v161 offset:49152
    v_mfma_f32_32x32x16_bf16 v[96:111], v[136:139], v[116:119], v[96:111]
    ds_read_b64_tr_b16 v[40:41], v164 offset:39936
    ds_read_b64_tr_b16 v[42:43], v164 offset:40192
    ds_read_b128 v[24:27], v162 offset:49152
    ds_read_b64_tr_b16 v[48:49], v164 offset:43008
    v_mfma_f32_32x32x16_bf16 v[96:111], v[144:147], v[120:123], v[96:111]
    ds_read_b64_tr_b16 v[50:51], v164 offset:43264
    ds_read_b128 v[28:31], v163 offset:49152
    ds_read_b64_tr_b16 v[56:57], v164 offset:46080
    ds_read_b64_tr_b16 v[58:59], v164 offset:46336
    v_mfma_f32_32x32x16_bf16 v[96:111], v[152:155], v[124:127], v[96:111]
    s_and_b32 s8, s85, 7
    s_add_u32 s85, s85, 1
    s_mul_i32 s8, s8, s86
    s_add_u32 m0, s83, 16384
    s_add_u32 s8, s8, s82
    buffer_load_dwordx4 v166, s[44:47], s8 offen offset:0 lds
    buffer_load_dwordx4 v167, s[44:47], s8 offen offset:1024 lds
    buffer_load_dwordx4 v168, s[44:47], s8 offen offset:2048 lds
    buffer_load_dwordx4 v169, s[44:47], s8 offen offset:3072 lds
    s_and_b32 s18, s3, 1
    s_lshr_b32 s19, s3, 1
    s_lshl_b32 s20, s6, 1
    s_add_u32 s20, s20, s19
    s_lshl_b32 s8, s20, 17
    s_add_u32 s8, s8, 2097152
    s_add_u32 s48, s38, s8
    s_addc_u32 s49, s39, 0
    s_mov_b32 s50, 0x20000
    s_mov_b32 s51, 0x00020000
    s_add_u32 s30, s48, 12582912
    s_addc_u32 s31, s49, 0
    s_mul_i32 s21, s3, 2080
    s_add_u32 s21, s21, 98304
    v_lshlrev_b32 v2, 4, v0
    v_add_u32 v3, s21, v2
    v_lshrrev_b32 v8, 5, v0
    v_lshlrev_b32 v8, 8, v8
    v_and_b32 v9, 15, v0
    v_lshl_add_u32 v8, v9, 4, v8
    v_add_u32 v8, 1024, v8
    v_add_u32 v9, 512, v8
    v_and_b32 v10, 27, v0
    v_cmp_eq_u32 vcc, 16, v10
    v_mov_b32 v11, 2064
    v_mov_b32 v12, 2048
    v_cndmask_b32 v11, v11, v12, vcc
    v_and_b32 v10, 16, v0
    v_cmp_eq_u32 vcc, 0, v10
    s_lshl_b32 s8, s19, 12
    s_add_u32 s8, s8, 148224
    v_cndmask_b32 v8, v11, v8, vcc
    v_cndmask_b32 v9, v11, v9, vcc
    v_add_u32 v4, s21, v8
    v_add_u32 v5, s21, v9
    v_add_u32 v6, s8, v2
    s_lshl_b32 s8, s7, 2
    s_add_u32 s8, s8, 4
    v_add_u32 v7, s8, v0
    v_and_b32 v7, 63, v7
    v_lshrrev_b32 v8, 2, v7
    v_and_b32 v7, 3, v7
    v_lshlrev_b32 v7, 3, v7
    v_lshl_add_u32 v7, v8, 7, v7
    s_lshl_b32 s27, 0x555, s18
    s_lshl_b32 s8, s19, 10
    s_add_u32 s8, s8, 156672
    v_add_u32 v1, s8, v2
    v_lshrrev_b32 v8, 3, v0
    v_min_u32 v8, 5, v8
    v_mul_u32_u24 v8, 8320, v8
    v_and_b32 v9, 7, v0
    v_lshl_add_u32 v8, v9, 2, v8
    v_cmp_gt_u32 vcc, 4, v9
    v_add_u32 v230, s21, v8
    v_mov_b32 v10, 0x3f803f80
    v_cndmask_b32 v231, 0, v10, vcc
    s_lshl_b32 s8, s7, 1
    s_add_u32 s8, s8, s18
    s_lshl_b32 s9, s8, 8
    s_add_u32 s32, s9, 12582912
    s_lshl_b32 s9, s8, 6
    s_add_u32 s33, s9, 12648448
    v_and_b32 v232, 31, v0
    v_lshlrev_b32 v232, 2, v232
    v_and_b32 v233, 7, v0
    v_lshlrev_b32 v233, 3, v233
    s_lshl_b32 s22, s6, 11
    s_add_u32 s22, s22, 12713984
    s_add_u32 s28, s22, 32768
    s_lshl_b32 s23, 0x55555555, s18
    s_mov_b32 s24, 0
    s_mov_b32 s25, 2
    s_waitcnt lgkmcnt(0)
    v_mfma_f32_32x32x16_bf16 v[96:111], v[32:35], v[16:19], v[96:111]
    s_waitcnt vmcnt(4)
    s_barrier
    ds_read_b128 v[112:115], v160 offset:0
    ds_read_b64_tr_b16 v[128:129], v164 offset:0
    ds_read_b64_tr_b16 v[130:131], v164 offset:256
    ds_read_b128 v[116:119], v161 offset:0
    v_mfma_f32_32x32x16_bf16 v[96:111], v[40:43], v[20:23], v[96:111]
    ds_read_b64_tr_b16 v[136:137], v164 offset:3072
    ds_read_b64_tr_b16 v[138:139], v164 offset:3328
    ds_read_b128 v[120:123], v162 offset:0
    ds_read_b64_tr_b16 v[144:145], v164 offset:6144
    v_mfma_f32_32x32x16_bf16 v[96:111], v[48:51], v[24:27], v[96:111]
    ds_read_b64_tr_b16 v[146:147], v164 offset:6400
    ds_read_b128 v[124:127], v163 offset:0
    ds_read_b64_tr_b16 v[152:153], v164 offset:9216
    ds_read_b64_tr_b16 v[154:155], v164 offset:9472
    v_mfma_f32_32x32x16_bf16 v[96:111], v[56:59], v[28:31], v[96:111]
    s_and_b32 s8, s85, 7
    s_add_u32 s85, s85, 1
    s_mul_i32 s8, s8, s86
    s_add_u32 m0, s83, 32768
    s_add_u32 s8, s8, s82
    buffer_load_dwordx4 v166, s[44:47], s8 offen offset:0 lds
    buffer_load_dwordx4 v167, s[44:47], s8 offen offset:1024 lds
    buffer_load_dwordx4 v168, s[44:47], s8 offen offset:2048 lds
    buffer_load_dwordx4 v169, s[44:47], s8 offen offset:3072 lds
    s_mov_b32 s17, 200000
L_tagl_7:
    v_readfirstlane_b32 s14, v216
    v_readfirstlane_b32 s15, v217
    s_cmp_lg_u32 s14, 0
    s_cbranch_scc1 L_tagok_8
    buffer_load_dwordx2 v[216:217], v210, s[92:95], 0 offen sc1
    s_waitcnt vmcnt(0)
    s_sub_u32 s17, s17, 1
    s_cmp_lg_u32 s17, 0
    s_cbranch_scc1 L_tagl_7
    s_endpgm
L_tagok_8:
    s_getreg_b32 s8, hwreg(HW_REG_XCC_ID)
    s_and_b32 s8, s8, 15
    s_add_u32 s8, s8, 1
    s_lshl_b32 s8, s8, 24
    s_mov_b32 s76, s14
    s_xor_b32 s77, s15, s8
    s_waitcnt lgkmcnt(0)
    v_mfma_f32_32x32x16_bf16 v[96:111], v[128:131], v[112:115], v[96:111]
    s_waitcnt vmcnt(4)
    s_barrier
    ds_read_b128 v[16:19], v160 offset:16384
    ds_read_b64_tr_b16 v[32:33], v164 offset:12288
    ds_read_b64_tr_b16 v[34:35], v164 offset:12544
    ds_read_b128 v[20:23], v161 offset:16384
    v_mfma_f32_32x32x16_bf16 v[96:111], v[136:139], v[116:119], v[96:111]
    ds_read_b64_tr_b16 v[40:41], v164 offset:15360
    ds_read_b64_tr_b16 v[42:43], v164 offset:15616
    ds_read_b128 v[24:27], v162 offset:16384
    ds_read_b64_tr_b16 v[48:49], v164 offset:18432
    v_mfma_f32_32x32x16_bf16 v[96:111], v[144:147], v[120:123], v[96:111]
    ds_read_b64_tr_b16 v[50:51], v164 offset:18688
    ds_read_b128 v[28:31], v163 offset:16384
    ds_read_b64_tr_b16 v[56:57], v164 offset:21504
    ds_read_b64_tr_b16 v[58:59], v164 offset:21760
    v_mfma_f32_32x32x16_bf16 v[96:111], v[152:155], v[124:127], v[96:111]
    s_and_b32 s8, s85, 7
    s_add_u32 s85, s85, 1
    s_mul_i32 s8, s8, s86
    s_add_u32 m0, s83, 49152
    s_add_u32 s8, s8, s82
    buffer_load_dwordx4 v166, s[44:47], s8 offen offset:0 lds
    buffer_load_dwordx4 v167, s[44:47], s8 offen offset:1024 lds
    buffer_load_dwordx4 v168, s[44:47], s8 offen offset:2048 lds
    buffer_load_dwordx4 v169, s[44:47], s8 offen offset:3072 lds
    s_waitcnt lgkmcnt(0)
    v_mfma_f32_32x32x16_bf16 v[96:111], v[32:35], v[16:19], v[96:111]
    s_waitcnt vmcnt(4)
    s_barrier
    ds_read_b128 v[112:115], v160 offset:32768
    ds_read_b64_tr_b16 v[128:129], v164 offset:24576
    ds_read_b64_tr_b16 v[130:131], v164 offset:24832
    ds_read_b128 v[116:119], v161 offset:32768
    v_mfma_f32_32x32x16_bf16 v[96:111], v[40:43], v[20:23], v[96:111]
    ds_read_b64_tr_b16 v[136:137], v164 offset:27648
    ds_read_b64_tr_b16 v[138:139], v164 offset:27904
    ds_read_b128 v[120:123], v162 offset:32768
    ds_read_b64_tr_b16 v[144:145], v164 offset:30720
    v_mfma_f32_32x32x16_bf16 v[96:111], v[48:51], v[24:27], v[96:111]
    ds_read_b64_tr_b16 v[146:147], v164 offset:30976
    ds_read_b128 v[124:127], v163 offset:32768
    ds_read_b64_tr_b16 v[152:153], v164 offset:33792
    ds_read_b64_tr_b16 v[154:155], v164 offset:34048
    v_mfma_f32_32x32x16_bf16 v[96:111], v[56:59], v[28:31], v[96:111]
    s_lshl_b32 s8, s6, 18
    s_lshl_b32 s9, s84, 11
    s_add_u32 s8, s8, s9
    s_add_u32 s8, s8, 2097152
    s_add_u32 s9, s8, 0x20000
    buffer_load_dwordx4 v[248:251], v170, s[60:63], s8 offen offset:1024 nt
    buffer_load_dwordx4 v[248:251], v170, s[60:63], s9 offen offset:1024 nt
    buffer_load_dwordx2 v[248:249], v7, s[60:63], s22 offen nt
    s_add_u32 s8, s87, 0
    buffer_load_dwordx4 v[248:251], v174, s[52:55], s8 offen
    s_waitcnt lgkmcnt(0)
    v_mfma_f32_32x32x16_bf16 v[96:111], v[128:131], v[112:115], v[96:111]
    s_waitcnt vmcnt(4)
    s_barrier
    ds_read_b128 v[16:19], v160 offset:49152
    ds_read_b64_tr_b16 v[32:33], v164 offset:36864
    ds_read_b64_tr_b16 v[34:35], v164 offset:37120
    ds_read_b128 v[20:23], v161 offset:49152
    v_mfma_f32_32x32x16_bf16 v[96:111], v[136:139], v[116:119], v[96:111]
    ds_read_b64_tr_b16 v[40:41], v164 offset:39936
    ds_read_b64_tr_b16 v[42:43], v164 offset:40192
    ds_read_b128 v[24:27], v162 offset:49152
    ds_read_b64_tr_b16 v[48:49], v164 offset:43008
    v_mfma_f32_32x32x16_bf16 v[96:111], v[144:147], v[120:123], v[96:111]
    ds_read_b64_tr_b16 v[50:51], v164 offset:43264
    ds_read_b128 v[28:31], v163 offset:49152
    ds_read_b64_tr_b16 v[56:57], v164 offset:46080
    ds_read_b64_tr_b16 v[58:59], v164 offset:46336
    v_mfma_f32_32x32x16_bf16 v[96:111], v[152:155], v[124:127], v[96:111]
    s_waitcnt lgkmcnt(0)
    v_mfma_f32_32x32x16_bf16 v[96:111], v[32:35], v[16:19], v[96:111]
    v_mfma_f32_32x32x16_bf16 v[96:111], v[40:43], v[20:23], v[96:111]
    v_mfma_f32_32x32x16_bf16 v[96:111], v[48:51], v[24:27], v[96:111]
    v_mfma_f32_32x32x16_bf16 v[96:111], v[56:59], v[28:31], v[96:111]
    s_mov_b32 s8, 0x3eb8aa3b
    s_mov_b32 s9, 0x3eb8aa3b
    s_nop 9
    v_pk_mul_f32 v[96:97], v[96:97], s[8:9]
    v_pk_mul_f32 v[98:99], v[98:99], s[8:9]
    v_pk_mul_f32 v[100:101], v[100:101], s[8:9]
    v_pk_mul_f32 v[102:103], v[102:103], s[8:9]
    v_pk_mul_f32 v[104:105], v[104:105], s[8:9]
    v_pk_mul_f32 v[106:107], v[106:107], s[8:9]
    v_pk_mul_f32 v[108:109], v[108:109], s[8:9]
    v_pk_mul_f32 v[110:111], v[110:111], s[8:9]
    v_cvt_pk_bf16_f32 v112, v96, v97
    v_cvt_pk_bf16_f32 v113, v98, v99
    v_cvt_pk_bf16_f32 v114, v100, v101
    v_cvt_pk_bf16_f32 v115, v102, v103
    v_cvt_pk_bf16_f32 v116, v104, v105
    v_cvt_pk_bf16_f32 v117, v106, v107
    v_cvt_pk_bf16_f32 v118, v108, v109
    v_cvt_pk_bf16_f32 v119, v110, v111
    ds_write_b128 v171, v[112:115]
    ds_write_b128 v171, v[116:119] offset:4096
    s_waitcnt lgkmcnt(0)
    s_barrier
    s_setprio 2
    ds_write_b32 v230, v231 offset:2048
    ds_read_b128 v[16:19], v6 offset:0
    ds_read_b128 v[20:23], v6 offset:1024
    ds_read_b128 v[24:27], v6 offset:2048
    ds_read_b128 v[28:31], v6 offset:3072
    ds_read_b128 v[160:163], v1
    s_waitcnt lgkmcnt(0)
    v_mfma_f32_32x32x16_bf16 v[96:111], v[160:163], v[16:19], 0
    v_mfma_f32_32x32x16_bf16 v[112:127], v[160:163], v[20:23], 0
    v_mfma_f32_32x32x16_bf16 v[128:143], v[160:163], v[24:27], 0
    v_mfma_f32_32x32x16_bf16 v[144:159], v[160:163], v[28:31], 0
    ds_read_b128 v[200:203], v3 offset:33280
    ds_read_b128 v[208:211], v4 offset:33280
    ds_read_b128 v[212:215], v5 offset:33280
    s_nop 5
    v_max3_f32 v12, v96, v97, v98
    v_max3_f32 v12, v99, v100, v12
    v_max3_f32 v12, v101, v102, v12
    v_max3_f32 v12, v103, v104, v12
    v_max3_f32 v12, v105, v106, v12
    v_max3_f32 v12, v107, v108, v12
    v_max3_f32 v12, v109, v110, v12
    v_max_f32 v12, v111, v12
    v_max3_f32 v13, v112, v113, v114
    v_max3_f32 v13, v115, v116, v13
    v_max3_f32 v13, v117, v118, v13
    v_max3_f32 v13, v119, v120, v13
    v_max3_f32 v13, v121, v122, v13
    v_max3_f32 v13, v123, v124, v13
    v_max3_f32 v13, v125, v126, v13
    v_max_f32 v13, v127, v13
    v_max3_f32 v14, v128, v129, v130
    v_max3_f32 v14, v131, v132, v14
    v_max3_f32 v14, v133, v134, v14
    v_max3_f32 v14, v135, v136, v14
    v_max3_f32 v14, v137, v138, v14
    v_max3_f32 v14, v139, v140, v14
    v_max3_f32 v14, v141, v142, v14
    v_max_f32 v14, v143, v14
    v_max3_f32 v15, v144, v145, v146
    v_max3_f32 v15, v147, v148, v15
    v_max3_f32 v15, v149, v150, v15
    v_max3_f32 v15, v151, v152, v15
    v_max3_f32 v15, v153, v154, v15
    v_max3_f32 v15, v155, v156, v15
    v_max3_f32 v15, v157, v158, v15
    v_max_f32 v15, v159, v15
L_redo_9:
    v_mov_b32 v8, v12
    v_mov_b32 v9, v13
    v_mov_b32 v10, v14
    v_mov_b32 v11, v15
    s_nop 1
    v_permlane32_swap_b32 v12, v8
    v_permlane32_swap_b32 v13, v9
    v_permlane32_swap_b32 v14, v10
    v_permlane32_swap_b32 v15, v11
    s_nop 1
    v_max_f32 v12, v12, v8
    v_max_f32 v13, v13, v9
    v_max_f32 v14, v14, v10
    v_max_f32 v15, v15, v11
    v_sub_f32 v96, 0, v12
    v_sub_f32 v97, 0, v12
    v_sub_f32 v112, 0, v13
    v_sub_f32 v113, 0, v13
    v_sub_f32 v128, 0, v14
    v_sub_f32 v129, 0, v14
    v_sub_f32 v144, 0, v15
    v_sub_f32 v145, 0, v15
    v_mov_b64 v[98:99], v[96:97]
    v_mov_b64 v[100:101], v[96:97]
    v_mov_b64 v[102:103], v[96:97]
    v_mov_b64 v[104:105], v[96:97]
    v_mov_b64 v[106:107], v[96:97]
    v_mov_b64 v[108:109], v[96:97]
    v_mov_b64 v[110:111], v[96:97]
    s_nop 0
    s_waitcnt lgkmcnt(0)
    v_mfma_f32_32x32x16_bf16 v[160:175], v[200:203], v[16:19], v[96:111]
    v_mov_b64 v[114:115], v[112:113]
    v_mov_b64 v[116:117], v[112:113]
    v_mov_b64 v[118:119], v[112:113]
    v_mov_b64 v[120:121], v[112:113]
    v_mov_b64 v[122:123], v[112:113]
    v_mov_b64 v[124:125], v[112:113]
    v_mov_b64 v[126:127], v[112:113]
    v_mov_b64 v[130:131], v[128:129]
    v_mov_b64 v[132:133], v[128:129]
    v_mov_b64 v[134:135], v[128:129]
    v_mov_b64 v[136:137], v[128:129]
    v_mov_b64 v[138:139], v[128:129]
    v_mov_b64 v[140:141], v[128:129]
    v_mov_b64 v[142:143], v[128:129]
    v_mov_b64 v[146:147], v[144:145]
    v_mov_b64 v[148:149], v[144:145]
    v_mov_b64 v[150:151], v[144:145]
    v_mov_b64 v[152:153], v[144:145]
    v_mov_b64 v[154:155], v[144:145]
    v_mov_b64 v[156:157], v[144:145]
    v_mov_b64 v[158:159], v[144:145]
    s_lshl_b32 s12, s7, 2
    s_add_u32 s12, s12, s18
    s_add_u32 s12, s12, 4
    s_lshl_b32 s12, s12, 11
    s_and_b32 s12, s12, 0x1ffff
    v_mov_b32 v224, 156452
    v_mov_b32 v225, 1
    v_exp_f32 v160, v160
    v_exp_f32 v161, v161
    v_exp_f32 v162, v162
    v_exp_f32 v163, v163
    v_exp_f32 v164, v164
    v_exp_f32 v165, v165
    v_exp_f32 v166, v166
    v_exp_f32 v167, v167
    v_mfma_f32_32x32x16_bf16 v[176:191], v[200:203], v[20:23], v[112:127]
    ds_read_b128 v[204:207], v3 offset:41600
    v_cvt_pk_bf16_f32 v192, v160, v161
    v_cvt_pk_bf16_f32 v193, v162, v163
    v_cvt_pk_bf16_f32 v194, v164, v165
    v_cvt_pk_bf16_f32 v195, v166, v167
    v_exp_f32 v168, v168
    v_exp_f32 v169, v169
    v_exp_f32 v170, v170
    v_exp_f32 v171, v171
    v_mfma_f32_32x32x16_bf16 v[32:47], v[208:211], v[192:195], 0
    ds_read_b128 v[216:219], v4 offset:41600
    v_exp_f32 v172, v172
    v_exp_f32 v173, v173
    v_exp_f32 v174, v174
    v_exp_f32 v175, v175
    v_cvt_pk_bf16_f32 v196, v168, v169
    v_cvt_pk_bf16_f32 v197, v170, v171
    v_cvt_pk_bf16_f32 v198, v172, v173
    v_cvt_pk_bf16_f32 v199, v174, v175
    v_exp_f32 v176, v176
    v_exp_f32 v177, v177
    v_mfma_f32_32x32x16_bf16 v[32:47], v[212:215], v[196:199], v[32:47]
    ds_read_b128 v[220:223], v5 offset:41600
    v_exp_f32 v178, v178
    v_exp_f32 v179, v179
    v_exp_f32 v180, v180
    v_exp_f32 v181, v181
    v_exp_f32 v182, v182
    v_exp_f32 v183, v183
    v_mfma_f32_32x32x16_bf16 v[160:175], v[200:203], v[24:27], v[128:143]
    buffer_load_dwordx2 v[8:9], v7, s[60:63], s22 offen sc1
    v_cvt_pk_bf16_f32 v192, v176, v177
    v_cvt_pk_bf16_f32 v193, v178, v179
    v_cvt_pk_bf16_f32 v194, v180, v181
    v_cvt_pk_bf16_f32 v195, v182, v183
    v_exp_f32 v184, v184
    v_exp_f32 v185, v185
    v_exp_f32 v186, v186
    v_exp_f32 v187, v187
    v_mfma_f32_32x32x16_bf16 v[48:63], v[208:211], v[192:195], 0
    buffer_load_dwordx2 v[228:229], v233, s[60:63], s33 offen sc1
    v_exp_f32 v188, v188
    v_exp_f32 v189, v189
    v_exp_f32 v190, v190
    v_exp_f32 v191, v191
    v_cvt_pk_bf16_f32 v196, v184, v185
    v_cvt_pk_bf16_f32 v197, v186, v187
    v_cvt_pk_bf16_f32 v198, v188, v189
    v_cvt_pk_bf16_f32 v199, v190, v191
    v_exp_f32 v160, v160
    v_exp_f32 v161, v161
    v_mfma_f32_32x32x16_bf16 v[48:63], v[212:215], v[196:199], v[48:63]
    v_exp_f32 v162, v162
    v_exp_f32 v163, v163
    v_exp_f32 v164, v164
    v_exp_f32 v165, v165
    v_exp_f32 v166, v166
    v_exp_f32 v167, v167
    v_mfma_f32_32x32x16_bf16 v[176:191], v[200:203], v[28:31], v[144:159]
    v_cvt_pk_bf16_f32 v192, v160, v161
    v_cvt_pk_bf16_f32 v193, v162, v163
    v_cvt_pk_bf16_f32 v194, v164, v165
    v_cvt_pk_bf16_f32 v195, v166, v167
    v_exp_f32 v168, v168
    v_exp_f32 v169, v169
    v_exp_f32 v170, v170
    v_exp_f32 v171, v171
    v_mfma_f32_32x32x16_bf16 v[64:79], v[208:211], v[192:195], 0
    v_exp_f32 v172, v172
    v_exp_f32 v173, v173
    v_exp_f32 v174, v174
    v_exp_f32 v175, v175
    v_cvt_pk_bf16_f32 v196, v168, v169
    v_cvt_pk_bf16_f32 v197, v170, v171
    v_cvt_pk_bf16_f32 v198, v172, v173
    v_cvt_pk_bf16_f32 v199, v174, v175
    v_exp_f32 v176, v176
    v_exp_f32 v177, v177
    v_mfma_f32_32x32x16_bf16 v[64:79], v[212:215], v[196:199], v[64:79]
    s_waitcnt lgkmcnt(0)
    v_exp_f32 v178, v178
    v_exp_f32 v179, v179
    v_exp_f32 v180, v180
    v_exp_f32 v181, v181
    v_exp_f32 v182, v182
    v_exp_f32 v183, v183
    v_mfma_f32_32x32x16_bf16 v[160:175], v[204:207], v[16:19], v[96:111]
    s_waitcnt vmcnt(0)
    v_cmp_ne_u64 vcc, s[76:77], v[8:9]
    s_and_b32 s10, vcc_lo, s23
    s_and_b32 s11, vcc_hi, s23
    s_or_b32 s10, s10, s11
    s_cmp_eq_u32 s10, 0
    s_cselect_b32 s13, 0, 5
    s_and_b32 s10, vcc_lo, s27
    s_cbranch_scc1 L_kvw_10
L_kvwb_11:
    v_cvt_pk_bf16_f32 v192, v176, v177
    v_cvt_pk_bf16_f32 v193, v178, v179
    v_cvt_pk_bf16_f32 v194, v180, v181
    v_cvt_pk_bf16_f32 v195, v182, v183
    v_exp_f32 v184, v184
    v_exp_f32 v185, v185
    v_exp_f32 v186, v186
    v_exp_f32 v187, v187
    v_mfma_f32_32x32x16_bf16 v[80:95], v[208:211], v[192:195], 0
    s_add_u32 m0, s21, 0
    s_nop 0
    buffer_load_dwordx4 v2, s[48:51], s12 offen sc1 lds
    v_exp_f32 v188, v188
    v_exp_f32 v189, v189
    v_exp_f32 v190, v190
    v_exp_f32 v191, v191
    v_cvt_pk_bf16_f32 v196, v184, v185
    v_cvt_pk_bf16_f32 v197, v186, v187
    v_cvt_pk_bf16_f32 v198, v188, v189
    v_cvt_pk_bf16_f32 v199, v190, v191
    v_exp_f32 v160, v160
    v_exp_f32 v161, v161
    v_mfma_f32_32x32x16_bf16 v[80:95], v[212:215], v[196:199], v[80:95]
    buffer_load_dwordx4 v2, s[48:51], s12 offen offset:1024 sc1 lds
    v_exp_f32 v162, v162
    v_exp_f32 v163, v163
    v_exp_f32 v164, v164
    v_exp_f32 v165, v165
    v_exp_f32 v166, v166
    v_exp_f32 v167, v167
    v_mfma_f32_32x32x16_bf16 v[176:191], v[204:207], v[20:23], v[112:127]
    s_add_u32 s12, s12, 4096
    s_and_b32 s12, s12, 0x1ffff
    s_add_u32 m0, s21, 8320
    s_nop 0
    buffer_load_dwordx4 v2, s[48:51], s12 offen sc1 lds
    v_cvt_pk_bf16_f32 v192, v160, v161
    v_cvt_pk_bf16_f32 v193, v162, v163
    v_cvt_pk_bf16_f32 v194, v164, v165
    v_cvt_pk_bf16_f32 v195, v166, v167
    v_exp_f32 v168, v168
    v_exp_f32 v169, v169
    v_exp_f32 v170, v170
    v_exp_f32 v171, v171
    v_mfma_f32_32x32x16_bf16 v[32:47], v[216:219], v[192:195], v[32:47]
    buffer_load_dwordx4 v2, s[48:51], s12 offen offset:1024 sc1 lds
    v_exp_f32 v172, v172
    v_exp_f32 v173, v173
    v_exp_f32 v174, v174
    v_exp_f32 v175, v175
    v_cvt_pk_bf16_f32 v196, v168, v169
    v_cvt_pk_bf16_f32 v197, v170, v171
    v_cvt_pk_bf16_f32 v198, v172, v173
    v_cvt_pk_bf16_f32 v199, v174, v175
    v_exp_f32 v176, v176
    v_exp_f32 v177, v177
    v_mfma_f32_32x32x16_bf16 v[32:47], v[220:223], v[196:199], v[32:47]
    s_add_u32 s12, s12, 4096
    s_and_b32 s12, s12, 0x1ffff
    s_add_u32 m0, s21, 16640
    s_nop 0
    buffer_load_dwordx4 v2, s[48:51], s12 offen sc1 lds
    v_exp_f32 v178, v178
    v_exp_f32 v179, v179
    v_exp_f32 v180, v180
    v_exp_f32 v181, v181
    v_exp_f32 v182, v182
    v_exp_f32 v183, v183
    v_mfma_f32_32x32x16_bf16 v[160:175], v[204:207], v[24:27], v[128:143]
    buffer_load_dwordx4 v2, s[48:51], s12 offen offset:1024 sc1 lds
    v_cvt_pk_bf16_f32 v192, v176, v177
    v_cvt_pk_bf16_f32 v193, v178, v179
    v_cvt_pk_bf16_f32 v194, v180, v181
    v_cvt_pk_bf16_f32 v195, v182, v183
    v_exp_f32 v184, v184
    v_exp_f32 v185, v185
    v_exp_f32 v186, v186
    v_exp_f32 v187, v187
    v_mfma_f32_32x32x16_bf16 v[48:63], v[216:219], v[192:195], v[48:63]
    s_add_u32 s12, s12, 4096
    s_and_b32 s12, s12, 0x1ffff
    s_add_u32 m0, s21, 24960
    s_nop 0
    buffer_load_dwordx4 v2, s[48:51], s12 offen sc1 lds
    v_exp_f32 v188, v188
    v_exp_f32 v189, v189
    v_exp_f32 v190, v190
    v_exp_f32 v191, v191
    v_cvt_pk_bf16_f32 v196, v184, v185
    v_cvt_pk_bf16_f32 v197, v186, v187
    v_cvt_pk_bf16_f32 v198, v188, v189
    v_cvt_pk_bf16_f32 v199, v190, v191
    v_exp_f32 v160, v160
    v_exp_f32 v161, v161
    v_mfma_f32_32x32x16_bf16 v[48:63], v[220:223], v[196:199], v[48:63]
    buffer_load_dwordx4 v2, s[48:51], s12 offen offset:1024 sc1 lds
    v_exp_f32 v162, v162
    v_exp_f32 v163, v163
    v_exp_f32 v164, v164
    v_exp_f32 v165, v165
    v_exp_f32 v166, v166
    v_exp_f32 v167, v167
    v_mfma_f32_32x32x16_bf16 v[176:191], v[204:207], v[28:31], v[144:159]
    s_add_u32 s12, s12, 4096
    s_and_b32 s12, s12, 0x1ffff
    s_add_u32 m0, s21, 33280
    s_nop 0
    buffer_load_dwordx4 v2, s[48:51], s12 offen sc1 lds
    v_cvt_pk_bf16_f32 v192, v160, v161
    v_cvt_pk_bf16_f32 v193, v162, v163
    v_cvt_pk_bf16_f32 v194, v164, v165
    v_cvt_pk_bf16_f32 v195, v166, v167
    v_exp_f32 v168, v168
    v_exp_f32 v169, v169
    v_exp_f32 v170, v170
    v_exp_f32 v171, v171
    v_mfma_f32_32x32x16_bf16 v[64:79], v[216:219], v[192:195], v[64:79]
    buffer_load_dwordx4 v2, s[48:51], s12 offen offset:1024 sc1 lds
    v_exp_f32 v172, v172
    v_exp_f32 v173, v173
    v_exp_f32 v174, v174
    v_exp_f32 v175, v175
    v_cvt_pk_bf16_f32 v196, v168, v169
    v_cvt_pk_bf16_f32 v197, v170, v171
    v_cvt_pk_bf16_f32 v198, v172, v173
    v_cvt_pk_bf16_f32 v199, v174, v175
    v_exp_f32 v176, v176
    v_exp_f32 v177, v177
    v_mfma_f32_32x32x16_bf16 v[64:79], v[220:223], v[196:199], v[64:79]
    s_add_u32 s12, s12, 4096
    s_and_b32 s12, s12, 0x1ffff
    s_add_u32 m0, s21, 41600
    s_nop 0
    buffer_load_dwordx4 v2, s[48:51], s12 offen sc1 lds
    v_exp_f32 v178, v178
    v_exp_f32 v179, v179
    v_exp_f32 v180, v180
    v_exp_f32 v181, v181
    v_exp_f32 v182, v182
    v_exp_f32 v183, v183
    s_nop 0
    v_cvt_pk_bf16_f32 v192, v176, v177
    v_cvt_pk_bf16_f32 v193, v178, v179
    v_cvt_pk_bf16_f32 v194, v180, v181
    v_cvt_pk_bf16_f32 v195, v182, v183
    v_exp_f32 v184, v184
    v_exp_f32 v185, v185
    v_exp_f32 v186, v186
    v_exp_f32 v187, v187
    v_mfma_f32_32x32x16_bf16 v[80:95], v[216:219], v[192:195], v[80:95]
    buffer_load_dwordx4 v2, s[48:51], s12 offen offset:1024 sc1 lds
    v_exp_f32 v188, v188
    v_exp_f32 v189, v189
    v_exp_f32 v190, v190
    v_exp_f32 v191, v191
    v_cvt_pk_bf16_f32 v196, v184, v185
    v_cvt_pk_bf16_f32 v197, v186, v187
    v_cvt_pk_bf16_f32 v198, v188, v189
    v_cvt_pk_bf16_f32 v199, v190, v191
    s_add_u32 s12, s12, 4096
    s_and_b32 s12, s12, 0x1ffff
    v_cmp_ne_u64 vcc, s[14:15], v[228:229]
    s_and_b32 s10, vcc_lo, -1
    s_and_b32 s11, vcc_hi, -1
    s_or_b32 s10, s10, s11
    s_cmp_eq_u32 s10, 0
    s_cbranch_scc1 L_gok_12
    s_mov_b32 s17, 200000
L_poll_13:
    buffer_load_dwordx2 v[228:229], v233, s[60:63], s33 offen sc1
    s_waitcnt vmcnt(0)
    v_cmp_ne_u64 vcc, s[14:15], v[228:229]
    s_and_b32 s10, vcc_lo, -1
    s_and_b32 s11, vcc_hi, -1
    s_or_b32 s10, s10, s11
    s_cmp_eq_u32 s10, 0
    s_cbranch_scc1 L_pollok_14
    s_sleep 2
    s_sub_u32 s17, s17, 1
    s_cmp_lg_u32 s17, 0
    s_cbranch_scc1 L_poll_13
    s_endpgm
L_pollok_14:
L_gok_12:
    buffer_load_dwordx2 v[8:9], v7, s[60:63], s22 offen sc1
    buffer_load_dword v226, v232, s[60:63], s32 offen sc1
    buffer_load_dword v227, v232, s[60:63], s32 offen offset:128 sc1
    s_mov_b64 exec, 1
    ds_add_u32 v224, v225
    s_mov_b64 exec, -1
    s_waitcnt vmcnt(13)
    ds_read_b128 v[200:203], v3 offset:0
    ds_read_b128 v[208:211], v4 offset:0
    ds_read_b128 v[212:215], v5 offset:0
    s_mov_b32 s16, 5
    s_waitcnt lgkmcnt(0)
    v_mfma_f32_32x32x16_bf16 v[160:175], v[200:203], v[16:19], v[96:111]
    s_nop 10
.p2align 6
L_attn_15:
    v_exp_f32 v160, v160
    v_exp_f32 v161, v161
    v_mfma_f32_32x32x16_bf16 v[80:95], v[220:223], v[196:199], v[80:95]
    s_waitcnt vmcnt(8)
    v_exp_f32 v162, v162
    v_exp_f32 v163, v163
    v_exp_f32 v164, v164
    v_exp_f32 v165, v165
    v_exp_f32 v166, v166
    v_exp_f32 v167, v167
    v_mfma_f32_32x32x16_bf16 v[176:191], v[200:203], v[20:23], v[112:127]
    ds_read_b128 v[204:207], v3 offset:8320
    v_cvt_pk_bf16_f32 v192, v160, v161
    v_cvt_pk_bf16_f32 v193, v162, v163
    v_cvt_pk_bf16_f32 v194, v164, v165
    v_cvt_pk_bf16_f32 v195, v166, v167
    v_exp_f32 v168, v168
    v_exp_f32 v169, v169
    v_exp_f32 v170, v170
    v_exp_f32 v171, v171
    v_mfma_f32_32x32x16_bf16 v[32:47], v[208:211], v[192:195], v[32:47]
    ds_read_b128 v[216:219], v4 offset:8320
    v_exp_f32 v172, v172
    v_exp_f32 v173, v173
    v_exp_f32 v174, v174
    v_exp_f32 v175, v175
    v_cvt_pk_bf16_f32 v196, v168, v169
    v_cvt_pk_bf16_f32 v197, v170, v171
    v_cvt_pk_bf16_f32 v198, v172, v173
    v_cvt_pk_bf16_f32 v199, v174, v175
    v_exp_f32 v176, v176
    v_exp_f32 v177, v177
    v_mfma_f32_32x32x16_bf16 v[32:47], v[212:215], v[196:199], v[32:47]
    s_cmp_eq_u32 s16, s13
    ds_read_b128 v[220:223], v5 offset:8320
    v_exp_f32 v178, v178
    v_exp_f32 v179, v179
    v_exp_f32 v180, v180
    v_exp_f32 v181, v181
    v_exp_f32 v182, v182
    v_exp_f32 v183, v183
    v_mfma_f32_32x32x16_bf16 v[160:175], v[200:203], v[24:27], v[128:143]
    s_cbranch_scc1 L_chk_16
L_chkb_17:
    s_add_u32 m0, s21, 0
    v_cvt_pk_bf16_f32 v192, v176, v177
    v_cvt_pk_bf16_f32 v193, v178, v179
    v_cvt_pk_bf16_f32 v194, v180, v181
    v_cvt_pk_bf16_f32 v195, v182, v183
    v_exp_f32 v184, v184
    v_exp_f32 v185, v185
    v_exp_f32 v186, v186
    v_exp_f32 v187, v187
    v_mfma_f32_32x32x16_bf16 v[48:63], v[208:211], v[192:195], v[48:63]
    buffer_load_dwordx4 v2, s[48:51], s12 offen sc1 lds
    v_exp_f32 v188, v188
    v_exp_f32 v189, v189
    v_exp_f32 v190, v190
    v_exp_f32 v191, v191
    v_cvt_pk_bf16_f32 v196, v184, v185
    v_cvt_pk_bf16_f32 v197, v186, v187
    v_cvt_pk_bf16_f32 v198, v188, v189
    v_cvt_pk_bf16_f32 v199, v190, v191
    v_exp_f32 v160, v160
    v_exp_f32 v161, v161
    v_mfma_f32_32x32x16_bf16 v[48:63], v[212:215], v[196:199], v[48:63]
    buffer_load_dwordx4 v2, s[48:51], s12 offen offset:1024 sc1 lds
    v_exp_f32 v162, v162
    v_exp_f32 v163, v163
    v_exp_f32 v164, v164
    v_exp_f32 v165, v165
    v_exp_f32 v166, v166
    v_exp_f32 v167, v167
    v_mfma_f32_32x32x16_bf16 v[176:191], v[200:203], v[28:31], v[144:159]
    s_add_u32 s12, s12, 4096
    v_cvt_pk_bf16_f32 v192, v160, v161
    v_cvt_pk_bf16_f32 v193, v162, v163
    v_cvt_pk_bf16_f32 v194, v164, v165
    v_cvt_pk_bf16_f32 v195, v166, v167
    v_exp_f32 v168, v168
    v_exp_f32 v169, v169
    v_exp_f32 v170, v170
    v_exp_f32 v171, v171
    v_mfma_f32_32x32x16_bf16 v[64:79], v[208:211], v[192:195], v[64:79]
    s_and_b32 s12, s12, 0x1ffff
    v_exp_f32 v172, v172
    v_exp_f32 v173, v173
    v_exp_f32 v174, v174
    v_exp_f32 v175, v175
    v_cvt_pk_bf16_f32 v196, v168, v169
    v_cvt_pk_bf16_f32 v197, v170, v171
    v_cvt_pk_bf16_f32 v198, v172, v173
    v_cvt_pk_bf16_f32 v199, v174, v175
    v_exp_f32 v176, v176
    v_exp_f32 v177, v177
    v_mfma_f32_32x32x16_bf16 v[64:79], v[212:215], v[196:199], v[64:79]
    s_waitcnt lgkmcnt(0)
    v_exp_f32 v178, v178
    v_exp_f32 v179, v179
    v_exp_f32 v180, v180
    v_exp_f32 v181, v181
    v_exp_f32 v182, v182
    v_exp_f32 v183, v183
    v_mfma_f32_32x32x16_bf16 v[160:175], v[204:207], v[16:19], v[96:111]
    v_cvt_pk_bf16_f32 v192, v176, v177
    v_cvt_pk_bf16_f32 v193, v178, v179
    v_cvt_pk_bf16_f32 v194, v180, v181
    v_cvt_pk_bf16_f32 v195, v182, v183
    v_exp_f32 v184, v184
    v_exp_f32 v185, v185
    v_exp_f32 v186, v186
    v_exp_f32 v187, v187
    v_mfma_f32_32x32x16_bf16 v[80:95], v[208:211], v[192:195], v[80:95]
    v_exp_f32 v188, v188
    v_exp_f32 v189, v189
    v_exp_f32 v190, v190
    v_exp_f32 v191, v191
    v_cvt_pk_bf16_f32 v196, v184, v185
    v_cvt_pk_bf16_f32 v197, v186, v187
    v_cvt_pk_bf16_f32 v198, v188, v189
    v_cvt_pk_bf16_f32 v199, v190, v191
    v_exp_f32 v160, v160
    v_exp_f32 v161, v161
    v_mfma_f32_32x32x16_bf16 v[80:95], v[212:215], v[196:199], v[80:95]
    s_waitcnt vmcnt(8)
    v_exp_f32 v162, v162
    v_exp_f32 v163, v163
    v_exp_f32 v164, v164
    v_exp_f32 v165, v165
    v_exp_f32 v166, v166
    v_exp_f32 v167, v167
    v_mfma_f32_32x32x16_bf16 v[176:191], v[204:207], v[20:23], v[112:127]
    ds_read_b128 v[200:203], v3 offset:16640
    v_cvt_pk_bf16_f32 v192, v160, v161
    v_cvt_pk_bf16_f32 v193, v162, v163
    v_cvt_pk_bf16_f32 v194, v164, v165
    v_cvt_pk_bf16_f32 v195, v166, v167
    v_exp_f32 v168, v168
    v_exp_f32 v169, v169
    v_exp_f32 v170, v170
    v_exp_f32 v171, v171
    v_mfma_f32_32x32x16_bf16 v[32:47], v[216:219], v[192:195], v[32:47]
    ds_read_b128 v[208:211], v4 offset:16640
    v_exp_f32 v172, v172
    v_exp_f32 v173, v173
    v_exp_f32 v174, v174
    v_exp_f32 v175, v175
    v_cvt_pk_bf16_f32 v196, v168, v169
    v_cvt_pk_bf16_f32 v197, v170, v171
    v_cvt_pk_bf16_f32 v198, v172, v173
    v_cvt_pk_bf16_f32 v199, v174, v175
    v_exp_f32 v176, v176
    v_exp_f32 v177, v177
    v_mfma_f32_32x32x16_bf16 v[32:47], v[220:223], v[196:199], v[32:47]
    ds_read_b128 v[212:215], v5 offset:16640
    v_exp_f32 v178, v178
    v_exp_f32 v179, v179
    v_exp_f32 v180, v180
    v_exp_f32 v181, v181
    v_exp_f32 v182, v182
    v_exp_f32 v183, v183
    v_mfma_f32_32x32x16_bf16 v[160:175], v[204:207], v[24:27], v[128:143]
    s_add_u32 m0, s21, 8320
    v_cvt_pk_bf16_f32 v192, v176, v177
    v_cvt_pk_bf16_f32 v193, v178, v179
    v_cvt_pk_bf16_f32 v194, v180, v181
    v_cvt_pk_bf16_f32 v195, v182, v183
    v_exp_f32 v184, v184
    v_exp_f32 v185, v185
    v_exp_f32 v186, v186
    v_exp_f32 v187, v187
    v_mfma_f32_32x32x16_bf16 v[48:63], v[216:219], v[192:195], v[48:63]
    buffer_load_dwordx4 v2, s[48:51], s12 offen sc1 lds
    v_exp_f32 v188, v188
    v_exp_f32 v189, v189
    v_exp_f32 v190, v190
    v_exp_f32 v191, v191
    v_cvt_pk_bf16_f32 v196, v184, v185
    v_cvt_pk_bf16_f32 v197, v186, v187
    v_cvt_pk_bf16_f32 v198, v188, v189
    v_cvt_pk_bf16_f32 v199, v190, v191
    v_exp_f32 v160, v160
    v_exp_f32 v161, v161
    v_mfma_f32_32x32x16_bf16 v[48:63], v[220:223], v[196:199], v[48:63]
    buffer_load_dwordx4 v2, s[48:51], s12 offen offset:1024 sc1 lds
    v_exp_f32 v162, v162
    v_exp_f32 v163, v163
    v_exp_f32 v164, v164
    v_exp_f32 v165, v165
    v_exp_f32 v166, v166
    v_exp_f32 v167, v167
    v_mfma_f32_32x32x16_bf16 v[176:191], v[204:207], v[28:31], v[144:159]
    s_add_u32 s12, s12, 4096
    v_cvt_pk_bf16_f32 v192, v160, v161
    v_cvt_pk_bf16_f32 v193, v162, v163
    v_cvt_pk_bf16_f32 v194, v164, v165
    v_cvt_pk_bf16_f32 v195, v166, v167
    v_exp_f32 v168, v168
    v_exp_f32 v169, v169
    v_exp_f32 v170, v170
    v_exp_f32 v171, v171
    v_mfma_f32_32x32x16_bf16 v[64:79], v[216:219], v[192:195], v[64:79]
    s_and_b32 s12, s12, 0x1ffff
    v_exp_f32 v172, v172
    v_exp_f32 v173, v173
    v_exp_f32 v174, v174
    v_exp_f32 v175, v175
    v_cvt_pk_bf16_f32 v196, v168, v169
    v_cvt_pk_bf16_f32 v197, v170, v171
    v_cvt_pk_bf16_f32 v198, v172, v173
    v_cvt_pk_bf16_f32 v199, v174, v175
    v_exp_f32 v176, v176
    v_exp_f32 v177, v177
    v_mfma_f32_32x32x16_bf16 v[64:79], v[220:223], v[196:199], v[64:79]
    s_waitcnt lgkmcnt(0)
    v_exp_f32 v178, v178
    v_exp_f32 v179, v179
    v_exp_f32 v180, v180
    v_exp_f32 v181, v181
    v_exp_f32 v182, v182
    v_exp_f32 v183, v183
    v_mfma_f32_32x32x16_bf16 v[160:175], v[200:203], v[16:19], v[96:111]
    v_cvt_pk_bf16_f32 v192, v176, v177
    v_cvt_pk_bf16_f32 v193, v178, v179
    v_cvt_pk_bf16_f32 v194, v180, v181
    v_cvt_pk_bf16_f32 v195, v182, v183
    v_exp_f32 v184, v184
    v_exp_f32 v185, v185
    v_exp_f32 v186, v186
    v_exp_f32 v187, v187
    v_mfma_f32_32x32x16_bf16 v[80:95], v[216:219], v[192:195], v[80:95]
    v_exp_f32 v188, v188
    v_exp_f32 v189, v189
    v_exp_f32 v190, v190
    v_exp_f32 v191, v191
    v_cvt_pk_bf16_f32 v196, v184, v185
    v_cvt_pk_bf16_f32 v197, v186, v187
    v_cvt_pk_bf16_f32 v198, v188, v189
    v_cvt_pk_bf16_f32 v199, v190, v191
    v_exp_f32 v160, v160
    v_exp_f32 v161, v161
    v_mfma_f32_32x32x16_bf16 v[80:95], v[220:223], v[196:199], v[80:95]
    s_waitcnt vmcnt(8)
    v_exp_f32 v162, v162
    v_exp_f32 v163, v163
    v_exp_f32 v164, v164
    v_exp_f32 v165, v165
    v_exp_f32 v166, v166
    v_exp_f32 v167, v167
    v_mfma_f32_32x32x16_bf16 v[176:191], v[200:203], v[20:23], v[112:127]
    ds_read_b128 v[204:207], v3 offset:24960
    v_cvt_pk_bf16_f32 v192, v160, v161
    v_cvt_pk_bf16_f32 v193, v162, v163
    v_cvt_pk_bf16_f32 v194, v164, v165
    v_cvt_pk_bf16_f32 v195, v166, v167
    v_exp_f32 v168, v168
    v_exp_f32 v169, v169
    v_exp_f32 v170, v170
    v_exp_f32 v171, v171
    v_mfma_f32_32x32x16_bf16 v[32:47], v[208:211], v[192:195], v[32:47]
    ds_read_b128 v[216:219], v4 offset:24960
    v_exp_f32 v172, v172
    v_exp_f32 v173, v173
    v_exp_f32 v174, v174
    v_exp_f32 v175, v175
    v_cvt_pk_bf16_f32 v196, v168, v169
    v_cvt_pk_bf16_f32 v197, v170, v171
    v_cvt_pk_bf16_f32 v198, v172, v173
    v_cvt_pk_bf16_f32 v199, v174, v175
    v_exp_f32 v176, v176
    v_exp_f32 v177, v177
    v_mfma_f32_32x32x16_bf16 v[32:47], v[212:215], v[196:199], v[32:47]
    ds_read_b128 v[220:223], v5 offset:24960
    v_exp_f32 v178, v178
    v_exp_f32 v179, v179
    v_exp_f32 v180, v180
    v_exp_f32 v181, v181
    v_exp_f32 v182, v182
    v_exp_f32 v183, v183
    v_mfma_f32_32x32x16_bf16 v[160:175], v[200:203], v[24:27], v[128:143]
    s_add_u32 m0, s21, 16640
    v_cvt_pk_bf16_f32 v192, v176, v177
    v_cvt_pk_bf16_f32 v193, v178, v179
    v_cvt_pk_bf16_f32 v194, v180, v181
    v_cvt_pk_bf16_f32 v195, v182, v183
    v_exp_f32 v184, v184
    v_exp_f32 v185, v185
    v_exp_f32 v186, v186
    v_exp_f32 v187, v187
    v_mfma_f32_32x32x16_bf16 v[48:63], v[208:211], v[192:195], v[48:63]
    buffer_load_dwordx4 v2, s[48:51], s12 offen sc1 lds
    v_exp_f32 v188, v188
    v_exp_f32 v189, v189
    v_exp_f32 v190, v190
    v_exp_f32 v191, v191
    v_cvt_pk_bf16_f32 v196, v184, v185
    v_cvt_pk_bf16_f32 v197, v186, v187
    v_cvt_pk_bf16_f32 v198, v188, v189
    v_cvt_pk_bf16_f32 v199, v190, v191
    v_exp_f32 v160, v160
    v_exp_f32 v161, v161
    v_mfma_f32_32x32x16_bf16 v[48:63], v[212:215], v[196:199], v[48:63]
    buffer_load_dwordx4 v2, s[48:51], s12 offen offset:1024 sc1 lds
    v_exp_f32 v162, v162
    v_exp_f32 v163, v163
    v_exp_f32 v164, v164
    v_exp_f32 v165, v165
    v_exp_f32 v166, v166
    v_exp_f32 v167, v167
    v_mfma_f32_32x32x16_bf16 v[176:191], v[200:203], v[28:31], v[144:159]
    s_add_u32 s12, s12, 4096
    v_cvt_pk_bf16_f32 v192, v160, v161
    v_cvt_pk_bf16_f32 v193, v162, v163
    v_cvt_pk_bf16_f32 v194, v164, v165
    v_cvt_pk_bf16_f32 v195, v166, v167
    v_exp_f32 v168, v168
    v_exp_f32 v169, v169
    v_exp_f32 v170, v170
    v_exp_f32 v171, v171
    v_mfma_f32_32x32x16_bf16 v[64:79], v[208:211], v[192:195], v[64:79]
    s_and_b32 s12, s12, 0x1ffff
    v_exp_f32 v172, v172
    v_exp_f32 v173, v173
    v_exp_f32 v174, v174
    v_exp_f32 v175, v175
    v_cvt_pk_bf16_f32 v196, v168, v169
    v_cvt_pk_bf16_f32 v197, v170, v171
    v_cvt_pk_bf16_f32 v198, v172, v173
    v_cvt_pk_bf16_f32 v199, v174, v175
    v_exp_f32 v176, v176
    v_exp_f32 v177, v177
    v_mfma_f32_32x32x16_bf16 v[64:79], v[212:215], v[196:199], v[64:79]
    s_waitcnt lgkmcnt(0)
    v_exp_f32 v178, v178
    v_exp_f32 v179, v179
    v_exp_f32 v180, v180
    v_exp_f32 v181, v181
    v_exp_f32 v182, v182
    v_exp_f32 v183, v183
    v_mfma_f32_32x32x16_bf16 v[160:175], v[204:207], v[16:19], v[96:111]
    v_cvt_pk_bf16_f32 v192, v176, v177
    v_cvt_pk_bf16_f32 v193, v178, v179
    v_cvt_pk_bf16_f32 v194, v180, v181
    v_cvt_pk_bf16_f32 v195, v182, v183
    v_exp_f32 v184, v184
    v_exp_f32 v185, v185
    v_exp_f32 v186, v186
    v_exp_f32 v187, v187
    v_mfma_f32_32x32x16_bf16 v[80:95], v[208:211], v[192:195], v[80:95]
    v_exp_f32 v188, v188
    v_exp_f32 v189, v189
    v_exp_f32 v190, v190
    v_exp_f32 v191, v191
    v_cvt_pk_bf16_f32 v196, v184, v185
    v_cvt_pk_bf16_f32 v197, v186, v187
    v_cvt_pk_bf16_f32 v198, v188, v189
    v_cvt_pk_bf16_f32 v199, v190, v191
    v_exp_f32 v160, v160
    v_exp_f32 v161, v161
    v_mfma_f32_32x32x16_bf16 v[80:95], v[212:215], v[196:199], v[80:95]
    s_waitcnt vmcnt(8)
    v_exp_f32 v162, v162
    v_exp_f32 v163, v163
    v_exp_f32 v164, v164
    v_exp_f32 v165, v165
    v_exp_f32 v166, v166
    v_exp_f32 v167, v167
    v_mfma_f32_32x32x16_bf16 v[176:191], v[204:207], v[20:23], v[112:127]
    ds_read_b128 v[200:203], v3 offset:33280
    v_cvt_pk_bf16_f32 v192, v160, v161
    v_cvt_pk_bf16_f32 v193, v162, v163
    v_cvt_pk_bf16_f32 v194, v164, v165
    v_cvt_pk_bf16_f32 v195, v166, v167
    v_exp_f32 v168, v168
    v_exp_f32 v169, v169
    v_exp_f32 v170, v170
    v_exp_f32 v171, v171
    v_mfma_f32_32x32x16_bf16 v[32:47], v[216:219], v[192:195], v[32:47]
    ds_read_b128 v[208:211], v4 offset:33280
    v_exp_f32 v172, v172
    v_exp_f32 v173, v173
    v_exp_f32 v174, v174
    v_exp_f32 v175, v175
    v_cvt_pk_bf16_f32 v196, v168, v169
    v_cvt_pk_bf16_f32 v197, v170, v171
    v_cvt_pk_bf16_f32 v198, v172, v173
    v_cvt_pk_bf16_f32 v199, v174, v175
    v_exp_f32 v176, v176
    v_exp_f32 v177, v177
    v_mfma_f32_32x32x16_bf16 v[32:47], v[220:223], v[196:199], v[32:47]
    ds_read_b128 v[212:215], v5 offset:33280
    v_exp_f32 v178, v178
    v_exp_f32 v179, v179
    v_exp_f32 v180, v180
    v_exp_f32 v181, v181
    v_exp_f32 v182, v182
    v_exp_f32 v183, v183
    v_mfma_f32_32x32x16_bf16 v[160:175], v[204:207], v[24:27], v[128:143]
    s_add_u32 m0, s21, 24960
    v_cvt_pk_bf16_f32 v192, v176, v177
    v_cvt_pk_bf16_f32 v193, v178, v179
    v_cvt_pk_bf16_f32 v194, v180, v181
    v_cvt_pk_bf16_f32 v195, v182, v183
    v_exp_f32 v184, v184
    v_exp_f32 v185, v185
    v_exp_f32 v186, v186
    v_exp_f32 v187, v187
    v_mfma_f32_32x32x16_bf16 v[48:63], v[216:219], v[192:195], v[48:63]
    buffer_load_dwordx4 v2, s[48:51], s12 offen sc1 lds
    v_exp_f32 v188, v188
    v_exp_f32 v189, v189
    v_exp_f32 v190, v190
    v_exp_f32 v191, v191
    v_cvt_pk_bf16_f32 v196, v184, v185
    v_cvt_pk_bf16_f32 v197, v186, v187
    v_cvt_pk_bf16_f32 v198, v188, v189
    v_cvt_pk_bf16_f32 v199, v190, v191
    v_exp_f32 v160, v160
    v_exp_f32 v161, v161
    v_mfma_f32_32x32x16_bf16 v[48:63], v[220:223], v[196:199], v[48:63]
    buffer_load_dwordx4 v2, s[48:51], s12 offen offset:1024 sc1 lds
    v_exp_f32 v162, v162
    v_exp_f32 v163, v163
    v_exp_f32 v164, v164
    v_exp_f32 v165, v165
    v_exp_f32 v166, v166
    v_exp_f32 v167, v167
    v_mfma_f32_32x32x16_bf16 v[176:191], v[204:207], v[28:31], v[144:159]
    s_add_u32 s12, s12, 4096
    v_cvt_pk_bf16_f32 v192, v160, v161
    v_cvt_pk_bf16_f32 v193, v162, v163
    v_cvt_pk_bf16_f32 v194, v164, v165
    v_cvt_pk_bf16_f32 v195, v166, v167
    v_exp_f32 v168, v168
    v_exp_f32 v169, v169
    v_exp_f32 v170, v170
    v_exp_f32 v171, v171
    v_mfma_f32_32x32x16_bf16 v[64:79], v[216:219], v[192:195], v[64:79]
    s_and_b32 s12, s12, 0x1ffff
    v_exp_f32 v172, v172
    v_exp_f32 v173, v173
    v_exp_f32 v174, v174
    v_exp_f32 v175, v175
    v_cvt_pk_bf16_f32 v196, v168, v169
    v_cvt_pk_bf16_f32 v197, v170, v171
    v_cvt_pk_bf16_f32 v198, v172, v173
    v_cvt_pk_bf16_f32 v199, v174, v175
    v_exp_f32 v176, v176
    v_exp_f32 v177, v177
    v_mfma_f32_32x32x16_bf16 v[64:79], v[220:223], v[196:199], v[64:79]
    s_waitcnt lgkmcnt(0)
    v_exp_f32 v178, v178
    v_exp_f32 v179, v179
    v_exp_f32 v180, v180
    v_exp_f32 v181, v181
    v_exp_f32 v182, v182
    v_exp_f32 v183, v183
    v_mfma_f32_32x32x16_bf16 v[160:175], v[200:203], v[16:19], v[96:111]
    v_cvt_pk_bf16_f32 v192, v176, v177
    v_cvt_pk_bf16_f32 v193, v178, v179
    v_cvt_pk_bf16_f32 v194, v180, v181
    v_cvt_pk_bf16_f32 v195, v182, v183
    v_exp_f32 v184, v184
    v_exp_f32 v185, v185
    v_exp_f32 v186, v186
    v_exp_f32 v187, v187
    v_mfma_f32_32x32x16_bf16 v[80:95], v[216:219], v[192:195], v[80:95]
    v_exp_f32 v188, v188
    v_exp_f32 v189, v189
    v_exp_f32 v190, v190
    v_exp_f32 v191, v191
    v_cvt_pk_bf16_f32 v196, v184, v185
    v_cvt_pk_bf16_f32 v197, v186, v187
    v_cvt_pk_bf16_f32 v198, v188, v189
    v_cvt_pk_bf16_f32 v199, v190, v191
    v_exp_f32 v160, v160
    v_exp_f32 v161, v161
    v_mfma_f32_32x32x16_bf16 v[80:95], v[220:223], v[196:199], v[80:95]
    s_waitcnt vmcnt(8)
    v_exp_f32 v162, v162
    v_exp_f32 v163, v163
    v_exp_f32 v164, v164
    v_exp_f32 v165, v165
    v_exp_f32 v166, v166
    v_exp_f32 v167, v167
    v_mfma_f32_32x32x16_bf16 v[176:191], v[200:203], v[20:23], v[112:127]
    ds_read_b128 v[204:207], v3 offset:41600
    v_cvt_pk_bf16_f32 v192, v160, v161
    v_cvt_pk_bf16_f32 v193, v162, v163
    v_cvt_pk_bf16_f32 v194, v164, v165
    v_cvt_pk_bf16_f32 v195, v166, v167
    v_exp_f32 v168, v168
    v_exp_f32 v169, v169
    v_exp_f32 v170, v170
    v_exp_f32 v171, v171
    v_mfma_f32_32x32x16_bf16 v[32:47], v[208:211], v[192:195], v[32:47]
    ds_read_b128 v[216:219], v4 offset:41600
    v_exp_f32 v172, v172
    v_exp_f32 v173, v173
    v_exp_f32 v174, v174
    v_exp_f32 v175, v175
    v_cvt_pk_bf16_f32 v196, v168, v169
    v_cvt_pk_bf16_f32 v197, v170, v171
    v_cvt_pk_bf16_f32 v198, v172, v173
    v_cvt_pk_bf16_f32 v199, v174, v175
    v_exp_f32 v176, v176
    v_exp_f32 v177, v177
    v_mfma_f32_32x32x16_bf16 v[32:47], v[212:215], v[196:199], v[32:47]
    ds_read_b128 v[220:223], v5 offset:41600
    v_exp_f32 v178, v178
    v_exp_f32 v179, v179
    v_exp_f32 v180, v180
    v_exp_f32 v181, v181
    v_exp_f32 v182, v182
    v_exp_f32 v183, v183
    v_mfma_f32_32x32x16_bf16 v[160:175], v[200:203], v[24:27], v[128:143]
    s_add_u32 m0, s21, 33280
    v_cvt_pk_bf16_f32 v192, v176, v177
    v_cvt_pk_bf16_f32 v193, v178, v179
    v_cvt_pk_bf16_f32 v194, v180, v181
    v_cvt_pk_bf16_f32 v195, v182, v183
    v_exp_f32 v184, v184
    v_exp_f32 v185, v185
    v_exp_f32 v186, v186
    v_exp_f32 v187, v187
    v_mfma_f32_32x32x16_bf16 v[48:63], v[208:211], v[192:195], v[48:63]
    buffer_load_dwordx4 v2, s[48:51], s12 offen sc1 lds
    v_exp_f32 v188, v188
    v_exp_f32 v189, v189
    v_exp_f32 v190, v190
    v_exp_f32 v191, v191
    v_cvt_pk_bf16_f32 v196, v184, v185
    v_cvt_pk_bf16_f32 v197, v186, v187
    v_cvt_pk_bf16_f32 v198, v188, v189
    v_cvt_pk_bf16_f32 v199, v190, v191
    v_exp_f32 v160, v160
    v_exp_f32 v161, v161
    v_mfma_f32_32x32x16_bf16 v[48:63], v[212:215], v[196:199], v[48:63]
    buffer_load_dwordx4 v2, s[48:51], s12 offen offset:1024 sc1 lds
    v_exp_f32 v162, v162
    v_exp_f32 v163, v163
    v_exp_f32 v164, v164
    v_exp_f32 v165, v165
    v_exp_f32 v166, v166
    v_exp_f32 v167, v167
    v_mfma_f32_32x32x16_bf16 v[176:191], v[200:203], v[28:31], v[144:159]
    s_add_u32 s12, s12, 4096
    v_cvt_pk_bf16_f32 v192, v160, v161
    v_cvt_pk_bf16_f32 v193, v162, v163
    v_cvt_pk_bf16_f32 v194, v164, v165
    v_cvt_pk_bf16_f32 v195, v166, v167
    v_exp_f32 v168, v168
    v_exp_f32 v169, v169
    v_exp_f32 v170, v170
    v_exp_f32 v171, v171
    v_mfma_f32_32x32x16_bf16 v[64:79], v[208:211], v[192:195], v[64:79]
    s_and_b32 s12, s12, 0x1ffff
    v_exp_f32 v172, v172
    v_exp_f32 v173, v173
    v_exp_f32 v174, v174
    v_exp_f32 v175, v175
    v_cvt_pk_bf16_f32 v196, v168, v169
    v_cvt_pk_bf16_f32 v197, v170, v171
    v_cvt_pk_bf16_f32 v198, v172, v173
    v_cvt_pk_bf16_f32 v199, v174, v175
    v_exp_f32 v176, v176
    v_exp_f32 v177, v177
    v_mfma_f32_32x32x16_bf16 v[64:79], v[212:215], v[196:199], v[64:79]
    s_waitcnt lgkmcnt(0)
    v_exp_f32 v178, v178
    v_exp_f32 v179, v179
    v_exp_f32 v180, v180
    v_exp_f32 v181, v181
    v_exp_f32 v182, v182
    v_exp_f32 v183, v183
    v_mfma_f32_32x32x16_bf16 v[160:175], v[204:207], v[16:19], v[96:111]
    s_sub_u32 s16, s16, 1
    v_cvt_pk_bf16_f32 v192, v176, v177
    v_cvt_pk_bf16_f32 v193, v178, v179
    v_cvt_pk_bf16_f32 v194, v180, v181
    v_cvt_pk_bf16_f32 v195, v182, v183
    v_exp_f32 v184, v184
    v_exp_f32 v185, v185
    v_exp_f32 v186, v186
    v_exp_f32 v187, v187
    v_mfma_f32_32x32x16_bf16 v[80:95], v[208:211], v[192:195], v[80:95]
    s_cmp_eq_u32 s16, 1
    v_exp_f32 v188, v188
    v_exp_f32 v189, v189
    v_exp_f32 v190, v190
    v_exp_f32 v191, v191
    v_cvt_pk_bf16_f32 v196, v184, v185
    v_cvt_pk_bf16_f32 v197, v186, v187
    v_cvt_pk_bf16_f32 v198, v188, v189
    v_cvt_pk_bf16_f32 v199, v190, v191
    v_exp_f32 v160, v160
    v_exp_f32 v161, v161
    v_mfma_f32_32x32x16_bf16 v[80:95], v[212:215], v[196:199], v[80:95]
    s_waitcnt vmcnt(8)
    s_cselect_b32 s26, 0, 0x20000
    v_exp_f32 v162, v162
    v_exp_f32 v163, v163
    v_exp_f32 v164, v164
    v_exp_f32 v165, v165
    v_exp_f32 v166, v166
    v_exp_f32 v167, v167
    v_mfma_f32_32x32x16_bf16 v[176:191], v[204:207], v[20:23], v[112:127]
    ds_read_b128 v[200:203], v3 offset:0
    v_cvt_pk_bf16_f32 v192, v160, v161
    v_cvt_pk_bf16_f32 v193, v162, v163
    v_cvt_pk_bf16_f32 v194, v164, v165
    v_cvt_pk_bf16_f32 v195, v166, v167
    v_exp_f32 v168, v168
    v_exp_f32 v169, v169
    v_exp_f32 v170, v170
    v_exp_f32 v171, v171
    v_mfma_f32_32x32x16_bf16 v[32:47], v[216:219], v[192:195], v[32:47]
    ds_read_b128 v[208:211], v4 offset:0
    v_exp_f32 v172, v172
    v_exp_f32 v173, v173
    v_exp_f32 v174, v174
    v_exp_f32 v175, v175
    v_cvt_pk_bf16_f32 v196, v168, v169
    v_cvt_pk_bf16_f32 v197, v170, v171
    v_cvt_pk_bf16_f32 v198, v172, v173
    v_cvt_pk_bf16_f32 v199, v174, v175
    v_exp_f32 v176, v176
    v_exp_f32 v177, v177
    v_mfma_f32_32x32x16_bf16 v[32:47], v[220:223], v[196:199], v[32:47]
    ds_read_b128 v[212:215], v5 offset:0
    v_exp_f32 v178, v178
    v_exp_f32 v179, v179
    v_exp_f32 v180, v180
    v_exp_f32 v181, v181
    v_exp_f32 v182, v182
    v_exp_f32 v183, v183
    v_mfma_f32_32x32x16_bf16 v[160:175], v[204:207], v[24:27], v[128:143]
    s_add_u32 m0, s21, 41600
    v_cvt_pk_bf16_f32 v192, v176, v177
    v_cvt_pk_bf16_f32 v193, v178, v179
    v_cvt_pk_bf16_f32 v194, v180, v181
    v_cvt_pk_bf16_f32 v195, v182, v183
    v_exp_f32 v184, v184
    v_exp_f32 v185, v185
    v_exp_f32 v186, v186
    v_exp_f32 v187, v187
    v_mfma_f32_32x32x16_bf16 v[48:63], v[216:219], v[192:195], v[48:63]
    buffer_load_dwordx4 v2, s[48:51], s12 offen sc1 lds
    v_exp_f32 v188, v188
    v_exp_f32 v189, v189
    v_exp_f32 v190, v190
    v_exp_f32 v191, v191
    v_cvt_pk_bf16_f32 v196, v184, v185
    v_cvt_pk_bf16_f32 v197, v186, v187
    v_cvt_pk_bf16_f32 v198, v188, v189
    v_cvt_pk_bf16_f32 v199, v190, v191
    v_exp_f32 v160, v160
    v_exp_f32 v161, v161
    v_mfma_f32_32x32x16_bf16 v[48:63], v[220:223], v[196:199], v[48:63]
    buffer_load_dwordx4 v2, s[48:51], s12 offen offset:1024 sc1 lds
    v_exp_f32 v162, v162
    v_exp_f32 v163, v163
    v_exp_f32 v164, v164
    v_exp_f32 v165, v165
    v_exp_f32 v166, v166
    v_exp_f32 v167, v167
    v_mfma_f32_32x32x16_bf16 v[176:191], v[204:207], v[28:31], v[144:159]
    s_add_u32 s12, s12, 4096
    v_cvt_pk_bf16_f32 v192, v160, v161
    v_cvt_pk_bf16_f32 v193, v162, v163
    v_cvt_pk_bf16_f32 v194, v164, v165
    v_cvt_pk_bf16_f32 v195, v166, v167
    v_exp_f32 v168, v168
    v_exp_f32 v169, v169
    v_exp_f32 v170, v170
    v_exp_f32 v171, v171
    v_mfma_f32_32x32x16_bf16 v[64:79], v[216:219], v[192:195], v[64:79]
    s_and_b32 s12, s12, 0x1ffff
    v_exp_f32 v172, v172
    v_exp_f32 v173, v173
    v_exp_f32 v174, v174
    v_exp_f32 v175, v175
    v_cvt_pk_bf16_f32 v196, v168, v169
    v_cvt_pk_bf16_f32 v197, v170, v171
    v_cvt_pk_bf16_f32 v198, v172, v173
    v_cvt_pk_bf16_f32 v199, v174, v175
    v_exp_f32 v176, v176
    v_exp_f32 v177, v177
    v_mfma_f32_32x32x16_bf16 v[64:79], v[220:223], v[196:199], v[64:79]
    s_waitcnt lgkmcnt(0)
    v_exp_f32 v178, v178
    v_exp_f32 v179, v179
    v_exp_f32 v180, v180
    v_exp_f32 v181, v181
    v_exp_f32 v182, v182
    v_exp_f32 v183, v183
    v_mfma_f32_32x32x16_bf16 v[160:175], v[200:203], v[16:19], v[96:111]
    s_mov_b32 s50, s26
    v_cvt_pk_bf16_f32 v192, v176, v177
    v_cvt_pk_bf16_f32 v193, v178, v179
    v_cvt_pk_bf16_f32 v194, v180, v181
    v_cvt_pk_bf16_f32 v195, v182, v183
    v_exp_f32 v184, v184
    v_exp_f32 v185, v185
    v_exp_f32 v186, v186
    v_exp_f32 v187, v187
    v_mfma_f32_32x32x16_bf16 v[80:95], v[216:219], v[192:195], v[80:95]
    s_cmp_lg_u32 s16, 0
    v_exp_f32 v188, v188
    v_exp_f32 v189, v189
    v_exp_f32 v190, v190
    v_exp_f32 v191, v191
    v_cvt_pk_bf16_f32 v196, v184, v185
    v_cvt_pk_bf16_f32 v197, v186, v187
    v_cvt_pk_bf16_f32 v198, v188, v189
    v_cvt_pk_bf16_f32 v199, v190, v191
    s_cbranch_scc1 L_attn_15
    s_nop 0
    v_mfma_f32_32x32x16_bf16 v[80:95], v[220:223], v[196:199], v[80:95]
    v_lshlrev_b32 v9, 2, v0
    v_add_u32 v9, s21, v9
    s_xor_b32 s8, s3, 1
    s_mul_i32 s8, s8, 2080
    s_add_u32 s8, s8, 98304
    v_add_u32 v10, s8, v2
    v_lshlrev_b32 v11, 2, v0
    v_add_u32 v11, s8, v11
    s_waitcnt vmcnt(0)
    s_nop 2
    v_add_f32 v8, v40, v56
    v_add_f32 v1, v72, v88
    v_add_f32 v8, v8, v1
    v_mov_b32 v1, 0x5d800000
    v_cmp_nlt_f32 vcc, v8, v1
    s_cmp_lg_u64 vcc, 0
    s_cselect_b32 s8, 0x10001, 1
    v_mov_b32 v1, s8
    s_cmp_eq_u32 s18, 1
    s_cbranch_scc1 L_kh1_18
    ds_write_b128 v3, v[64:67] offset:33280
    ds_write_b128 v3, v[68:71] offset:34304
    ds_write_b32 v9, v72 offset:41600
    ds_write_b128 v3, v[80:83] offset:0
    ds_write_b128 v3, v[84:87] offset:1024
    ds_write_b32 v9, v88 offset:8320
    s_branch L_khj_19
L_kh1_18:
    ds_write_b128 v3, v[32:35] offset:33280
    ds_write_b128 v3, v[36:39] offset:34304
    ds_write_b32 v9, v40 offset:41600
    ds_write_b128 v3, v[48:51] offset:0
    ds_write_b128 v3, v[52:55] offset:1024
    ds_write_b32 v9, v56 offset:8320
    s_waitcnt lgkmcnt(0)
    v_mov_b32 v32, v64
    v_mov_b32 v33, v65
    v_mov_b32 v34, v66
    v_mov_b32 v35, v67
    v_mov_b32 v36, v68
    v_mov_b32 v37, v69
    v_mov_b32 v38, v70
    v_mov_b32 v39, v71
    v_mov_b32 v40, v72
    v_mov_b32 v48, v80
    v_mov_b32 v49, v81
    v_mov_b32 v50, v82
    v_mov_b32 v51, v83
    v_mov_b32 v52, v84
    v_mov_b32 v53, v85
    v_mov_b32 v54, v86
    v_mov_b32 v55, v87
    v_mov_b32 v56, v88
L_khj_19:
    s_lshl_b32 s8, s19, 2
    s_add_u32 s8, s8, 156416
    v_mov_b32 v8, s8
    s_mov_b64 exec, 1
    ds_add_u32 v8, v1
    s_mov_b64 exec, -1
    s_mov_b32 s17, 3200000
L_asy_20:
    ds_read_b32 v9, v8
    s_waitcnt lgkmcnt(0)
    v_readfirstlane_b32 s8, v9
    s_and_b32 s9, s8, 0xffff
    s_cmp_ge_u32 s9, s25
    s_cbranch_scc1 L_asyd_21
    s_sub_u32 s17, s17, 1
    s_cmp_lg_u32 s17, 0
    s_cbranch_scc1 L_asy_20
    s_endpgm
L_asyd_21:
    s_lshr_b32 s9, s8, 16
    s_cmp_lg_u32 s9, 0
    s_cbranch_scc1 L_aslow_23
L_aok_22:
    ds_read_b128 v[160:163], v10 offset:33280
    ds_read_b128 v[164:167], v10 offset:34304
    ds_read_b32 v168, v11 offset:41600
    ds_read_b128 v[176:179], v10 offset:0
    ds_read_b128 v[180:183], v10 offset:1024
    ds_read_b32 v184, v11 offset:8320
    s_lshl_b32 s8, s7, 1
    s_add_u32 s8, s8, s18
    s_lshl_b32 s8, s8, 5
    s_add_u32 s8, s8, s20
    s_lshl_b32 s9, s7, 4
    s_add_u32 s9, s9, s6
    s_lshl_b32 s9, s9, 3
    s_add_u32 s9, s9, s18
    s_lshl_b32 s9, s9, 1
    s_add_u32 s9, s9, s19
    s_lshl_b32 s9, s9, 3
    s_add_u32 s9, s9, 12845056
    s_lshl_b32 s8, s8, 11
    s_add_u32 s8, s8, 10485760
    s_waitcnt lgkmcnt(0)
    v_add_f32 v40, v40, v168
    v_add_f32 v56, v56, v184
    v_rcp_f32 v40, v40
    v_rcp_f32 v56, v56
    v_add_f32 v32, v32, v160
    v_add_f32 v33, v33, v161
    v_add_f32 v34, v34, v162
    v_add_f32 v35, v35, v163
    v_add_f32 v36, v36, v164
    v_add_f32 v37, v37, v165
    v_add_f32 v38, v38, v166
    v_add_f32 v39, v39, v167
    v_add_f32 v48, v48, v176
    v_add_f32 v49, v49, v177
    v_add_f32 v50, v50, v178
    v_add_f32 v51, v51, v179
    v_add_f32 v52, v52, v180
    v_add_f32 v53, v53, v181
    v_add_f32 v54, v54, v182
    v_add_f32 v55, v55, v183
    v_mul_f32 v40, v40, v226
    v_mul_f32 v56, v56, v227
    v_mul_f32 v32, v32, v40
    v_mul_f32 v33, v33, v40
    v_mul_f32 v34, v34, v40
    v_mul_f32 v35, v35, v40
    v_mul_f32 v36, v36, v40
    v_mul_f32 v37, v37, v40
    v_mul_f32 v38, v38, v40
    v_mul_f32 v39, v39, v40
    v_cvt_pk_bf16_f32 v192, v32, v33
    v_cvt_pk_bf16_f32 v193, v34, v35
    v_cvt_pk_bf16_f32 v194, v36, v37
    v_cvt_pk_bf16_f32 v195, v38, v39
    buffer_store_dwordx4 v[192:195], v2, s[60:63], s8 offen offset:0 sc1
    v_mul_f32 v48, v48, v56
    v_mul_f32 v49, v49, v56
    v_mul_f32 v50, v50, v56
    v_mul_f32 v51, v51, v56
    v_mul_f32 v52, v52, v56
    v_mul_f32 v53, v53, v56
    v_mul_f32 v54, v54, v56
    v_mul_f32 v55, v55, v56
    v_cvt_pk_bf16_f32 v196, v48, v49
    v_cvt_pk_bf16_f32 v197, v50, v51
    v_cvt_pk_bf16_f32 v198, v52, v53
    v_cvt_pk_bf16_f32 v199, v54, v55
    buffer_store_dwordx4 v[196:199], v2, s[60:63], s8 offen offset:1024 sc1
    v_mov_b32 v10, s14
    v_mov_b32 v11, s15
    v_mov_b32 v9, 0
    s_mov_b64 exec, 1
    s_waitcnt vmcnt(0)
    buffer_store_dwordx2 v[10:11], v9, s[60:63], s9 offen sc1
    s_mov_b64 exec, -1
    s_endpgm
L_kvw_10:
    s_mov_b32 s17, 200000
L_kvp_24:
    buffer_load_dwordx2 v[8:9], v7, s[60:63], s22 offen sc1
    buffer_load_dwordx2 v[10:11], v7, s[60:63], s28 offen sc1
    s_waitcnt vmcnt(0)
    v_cmp_ne_u64 vcc, s[76:77], v[8:9]
    s_and_b32 s10, vcc_lo, s27
    s_and_b32 s11, vcc_hi, 0
    s_or_b32 s10, s10, s11
    s_cmp_eq_u32 s10, 0
    s_cbranch_scc1 L_kvok_25
    v_cmp_ne_u64 vcc, s[14:15], v[10:11]
    s_and_b32 s10, vcc_lo, s27
    s_and_b32 s11, vcc_hi, 0
    s_or_b32 s10, s10, s11
    s_cmp_eq_u32 s10, 0
    s_cbranch_scc1 L_kvs_26
    s_sleep 1
    s_sub_u32 s17, s17, 1
    s_cmp_lg_u32 s17, 0
    s_cbranch_scc1 L_kvp_24
    s_endpgm
L_kvs_26:
    s_mov_b32 s48, s30
    s_mov_b32 s49, s31
    s_mov_b32 s22, s28
    s_mov_b32 s77, s15
L_kvok_25:
    s_branch L_kvwb_11
L_chk_16:
    s_waitcnt vmcnt(0)
    v_cmp_ne_u64 vcc, s[76:77], v[8:9]
    s_and_b32 s10, vcc_lo, s23
    s_and_b32 s11, vcc_hi, s23
    s_or_b32 s10, s10, s11
    s_cmp_eq_u32 s10, 0
    s_cbranch_scc1 L_chkb_17
    s_mov_b32 s17, 200000
L_kvp_27:
    buffer_load_dwordx2 v[8:9], v7, s[60:63], s22 offen sc1
    buffer_load_dwordx2 v[10:11], v7, s[60:63], s28 offen sc1
    s_waitcnt vmcnt(0)
    v_cmp_ne_u64 vcc, s[76:77], v[8:9]
    s_and_b32 s10, vcc_lo, s23
    s_and_b32 s11, vcc_hi, s23
    s_or_b32 s10, s10, s11
    s_cmp_eq_u32 s10, 0
    s_cbranch_scc1 L_kvok_28
    v_cmp_ne_u64 vcc, s[14:15], v[10:11]
    s_and_b32 s10, vcc_lo, s23
    s_and_b32 s11, vcc_hi, s23
    s_or_b32 s10, s10, s11
    s_cmp_eq_u32 s10, 0
    s_cbranch_scc1 L_kvs_29
    s_sleep 1
    s_sub_u32 s17, s17, 1
    s_cmp_lg_u32 s17, 0
    s_cbranch_scc1 L_kvp_27
    s_endpgm
L_kvs_29:
    s_mov_b32 s48, s30
    s_mov_b32 s49, s31
    s_mov_b32 s22, s28
    s_mov_b32 s77, s15
L_kvok_28:
    s_branch L_chkb_17
L_aslow_23:
    s_cmp_lg_u32 s24, 0
    s_cbranch_scc1 L_aok_22
    s_mov_b32 s24, 1
    s_mov_b32 s25, 4
    s_mov_b32 s50, 0x20000
    s_mov_b32 s17, 200000
L_kvp_30:
    buffer_load_dwordx2 v[8:9], v7, s[60:63], s22 offen sc1
    buffer_load_dwordx2 v[10:11], v7, s[60:63], s28 offen sc1
    s_waitcnt vmcnt(0)
    v_cmp_ne_u64 vcc, s[76:77], v[8:9]
    s_and_b32 s10, vcc_lo, -1
    s_and_b32 s11, vcc_hi, -1
    s_or_b32 s10, s10, s11
    s_cmp_eq_u32 s10, 0
    s_cbranch_scc1 L_kvok_31
    v_cmp_ne_u64 vcc, s[14:15], v[10:11]
    s_and_b32 s10, vcc_lo, -1
    s_and_b32 s11, vcc_hi, -1
    s_or_b32 s10, s10, s11
    s_cmp_eq_u32 s10, 0
    s_cbranch_scc1 L_kvs_32
    s_sleep 1
    s_sub_u32 s17, s17, 1
    s_cmp_lg_u32 s17, 0
    s_cbranch_scc1 L_kvp_30
    s_endpgm
L_kvs_32:
    s_mov_b32 s48, s30
    s_mov_b32 s49, s31
    s_mov_b32 s22, s28
    s_mov_b32 s77, s15
L_kvok_31:
    v_mov_b32 v12, 0xff800000
    v_mov_b32 v13, 0xff800000
    v_mov_b32 v14, 0xff800000
    v_mov_b32 v15, 0xff800000
    s_mov_b32 s8, 0
L_maxloop_33:
    buffer_load_dwordx4 v[200:203], v2, s[48:51], s8 offen sc1
    s_waitcnt vmcnt(0)
    v_mfma_f32_32x32x16_bf16 v[96:111], v[200:203], v[16:19], 0
    v_mfma_f32_32x32x16_bf16 v[112:127], v[200:203], v[20:23], 0
    v_mfma_f32_32x32x16_bf16 v[128:143], v[200:203], v[24:27], 0
    v_mfma_f32_32x32x16_bf16 v[144:159], v[200:203], v[28:31], 0
    s_nop 9
    v_max3_f32 v12, v96, v97, v12
    v_max3_f32 v12, v98, v99, v12
    v_max3_f32 v12, v100, v101, v12
    v_max3_f32 v12, v102, v103, v12
    v_max3_f32 v12, v104, v105, v12
    v_max3_f32 v12, v106, v107, v12
    v_max3_f32 v12, v108, v109, v12
    v_max3_f32 v12, v110, v111, v12
    v_max3_f32 v13, v112, v113, v13
    v_max3_f32 v13, v114, v115, v13
    v_max3_f32 v13, v116, v117, v13
    v_max3_f32 v13, v118, v119, v13
    v_max3_f32 v13, v120, v121, v13
    v_max3_f32 v13, v122, v123, v13
    v_max3_f32 v13, v124, v125, v13
    v_max3_f32 v13, v126, v127, v13
    v_max3_f32 v14, v128, v129, v14
    v_max3_f32 v14, v130, v131, v14
    v_max3_f32 v14, v132, v133, v14
    v_max3_f32 v14, v134, v135, v14
    v_max3_f32 v14, v136, v137, v14
    v_max3_f32 v14, v138, v139, v14
    v_max3_f32 v14, v140, v141, v14
    v_max3_f32 v14, v142, v143, v14
    v_max3_f32 v15, v144, v145, v15
    v_max3_f32 v15, v146, v147, v15
    v_max3_f32 v15, v148, v149, v15
    v_max3_f32 v15, v150, v151, v15
    v_max3_f32 v15, v152, v153, v15
    v_max3_f32 v15, v154, v155, v15
    v_max3_f32 v15, v156, v157, v15
    v_max3_f32 v15, v158, v159, v15
    s_add_u32 s8, s8, 2048
    s_cmp_lt_u32 s8, 0x20000
    s_cbranch_scc1 L_maxloop_33
    s_lshl_b32 s12, s7, 2
    s_add_u32 s12, s12, s18
    s_lshl_b32 s12, s12, 11
    s_add_u32 m0, s21, 33280
    s_nop 0
    buffer_load_dwordx4 v2, s[48:51], s12 offen sc1 lds
    buffer_load_dwordx4 v2, s[48:51], s12 offen offset:1024 sc1 lds
    s_add_u32 s12, s12, 4096
    s_and_b32 s12, s12, 0x1ffff
    s_add_u32 m0, s21, 41600
    s_nop 0
    buffer_load_dwordx4 v2, s[48:51], s12 offen sc1 lds
    buffer_load_dwordx4 v2, s[48:51], s12 offen offset:1024 sc1 lds
    s_add_u32 s12, s12, 4096
    s_and_b32 s12, s12, 0x1ffff
    s_waitcnt vmcnt(0)
    ds_read_b128 v[200:203], v3 offset:33280
    ds_read_b128 v[208:211], v4 offset:33280
    ds_read_b128 v[212:215], v5 offset:33280
    s_branch L_redo_9
L_roleb:
    s_setprio 3
    s_waitcnt vmcnt(5)
    s_barrier
    ds_read_b128 v[112:115], v160 offset:0
    ds_read_b64_tr_b16 v[128:129], v164 offset:1024
    ds_read_b64_tr_b16 v[130:131], v164 offset:1280
    ds_read_b64_tr_b16 v[132:133], v164 offset:2048
    ds_read_b64_tr_b16 v[134:135], v164 offset:2304
    ds_read_b128 v[116:119], v161 offset:0
    ds_read_b64_tr_b16 v[136:137], v164 offset:4096
    ds_read_b64_tr_b16 v[138:139], v164 offset:4352
    ds_read_b64_tr_b16 v[140:141], v164 offset:5120
    ds_read_b64_tr_b16 v[142:143], v164 offset:5376
    ds_read_b128 v[120:123], v162 offset:0
    ds_read_b64_tr_b16 v[144:145], v164 offset:7168
    ds_read_b64_tr_b16 v[146:147], v164 offset:7424
    ds_read_b64_tr_b16 v[148:149], v164 offset:8192
    ds_read_b64_tr_b16 v[150:151], v164 offset:8448
    ds_read_b128 v[124:127], v163 offset:0
    ds_read_b64_tr_b16 v[152:153], v164 offset:10240
    ds_read_b64_tr_b16 v[154:155], v164 offset:10496
    ds_read_b64_tr_b16 v[156:157], v164 offset:11264
    ds_read_b64_tr_b16 v[158:159], v164 offset:11520
    s_and_b32 s8, s85, 7
    s_add_u32 s85, s85, 1
    s_mul_i32 s8, s8, s86
    s_add_u32 m0, s83, 24576
    s_add_u32 s8, s8, s82
    buffer_load_dwordx4 v166, s[44:47], s8 offen offset:0 lds
    buffer_load_dwordx4 v167, s[44:47], s8 offen offset:1024 lds
    buffer_load_dwordx4 v168, s[44:47], s8 offen offset:2048 lds
    s_waitcnt lgkmcnt(0)
    v_mfma_f32_32x32x16_bf16 v[80:95], v[128:131], v[112:115], 0
    s_waitcnt vmcnt(5)
    s_barrier
    ds_read_b128 v[16:19], v160 offset:16384
    ds_read_b64_tr_b16 v[32:33], v164 offset:13312
    ds_read_b64_tr_b16 v[34:35], v164 offset:13568
    ds_read_b64_tr_b16 v[36:37], v164 offset:14336
    v_mfma_f32_32x32x16_bf16 v[96:111], v[112:115], v[132:135], 0
    ds_read_b64_tr_b16 v[38:39], v164 offset:14592
    ds_read_b128 v[20:23], v161 offset:16384
    ds_read_b64_tr_b16 v[40:41], v164 offset:16384
    ds_read_b64_tr_b16 v[42:43], v164 offset:16640
    v_mfma_f32_32x32x16_bf16 v[80:95], v[136:139], v[116:119], v[80:95]
    ds_read_b64_tr_b16 v[44:45], v164 offset:17408
    ds_read_b64_tr_b16 v[46:47], v164 offset:17664
    ds_read_b128 v[24:27], v162 offset:16384
    ds_read_b64_tr_b16 v[48:49], v164 offset:19456
    v_mfma_f32_32x32x16_bf16 v[96:111], v[116:119], v[140:143], v[96:111]
    ds_read_b64_tr_b16 v[50:51], v164 offset:19712
    ds_read_b64_tr_b16 v[52:53], v164 offset:20480
    ds_read_b64_tr_b16 v[54:55], v164 offset:20736
    ds_read_b128 v[28:31], v163 offset:16384
    v_mfma_f32_32x32x16_bf16 v[80:95], v[144:147], v[120:123], v[80:95]
    ds_read_b64_tr_b16 v[56:57], v164 offset:22528
    ds_read_b64_tr_b16 v[58:59], v164 offset:22784
    ds_read_b64_tr_b16 v[60:61], v164 offset:23552
    ds_read_b64_tr_b16 v[62:63], v164 offset:23808
    v_mfma_f32_32x32x16_bf16 v[96:111], v[120:123], v[148:151], v[96:111]
    v_mfma_f32_32x32x16_bf16 v[80:95], v[152:155], v[124:127], v[80:95]
    v_mfma_f32_32x32x16_bf16 v[96:111], v[124:127], v[156:159], v[96:111]
    s_and_b32 s8, s85, 7
    s_add_u32 s85, s85, 1
    s_mul_i32 s8, s8, s86
    s_add_u32 m0, s83, 36864
    s_add_u32 s8, s8, s82
    buffer_load_dwordx4 v166, s[44:47], s8 offen offset:0 lds
    buffer_load_dwordx4 v167, s[44:47], s8 offen offset:1024 lds
    buffer_load_dwordx4 v168, s[44:47], s8 offen offset:2048 lds
    s_waitcnt vmcnt(6)
    v_lshlrev_b32 v184, 16, v176
    v_and_b32 v185, 0xffff0000, v176
    v_lshlrev_b32 v192, 16, v180
    v_and_b32 v193, 0xffff0000, v180
    v_lshlrev_b32 v186, 16, v177
    v_and_b32 v187, 0xffff0000, v177
    v_lshlrev_b32 v194, 16, v181
    v_and_b32 v195, 0xffff0000, v181
    v_lshlrev_b32 v188, 16, v178
    v_and_b32 v189, 0xffff0000, v178
    v_lshlrev_b32 v196, 16, v182
    v_and_b32 v197, 0xffff0000, v182
    v_lshlrev_b32 v190, 16, v179
    v_and_b32 v191, 0xffff0000, v179
    v_lshlrev_b32 v198, 16, v183
    v_and_b32 v199, 0xffff0000, v183
    v_add_f32 v200, v184, v185
    v_mul_f32 v201, v184, v192
    v_fmac_f32 v201, v185, v193
    v_add_f32 v200, v200, v186
    v_fmac_f32 v201, v186, v194
    v_add_f32 v200, v200, v187
    v_fmac_f32 v201, v187, v195
    v_add_f32 v200, v200, v188
    v_fmac_f32 v201, v188, v196
    v_add_f32 v200, v200, v189
    v_fmac_f32 v201, v189, v197
    v_add_f32 v200, v200, v190
    v_fmac_f32 v201, v190, v198
    v_add_f32 v200, v200, v191
    v_fmac_f32 v201, v191, v199
    s_nop 0
    s_nop 0
    v_add_f32_dpp v200, v200, v200 row_shr:1 row_mask:0xf bank_mask:0xf bound_ctrl:0
    v_add_f32_dpp v201, v201, v201 row_shr:1 row_mask:0xf bank_mask:0xf bound_ctrl:0
    s_nop 0
    v_add_f32_dpp v200, v200, v200 row_shr:2 row_mask:0xf bank_mask:0xf bound_ctrl:0
    v_add_f32_dpp v201, v201, v201 row_shr:2 row_mask:0xf bank_mask:0xf bound_ctrl:0
    s_nop 0
    v_add_f32_dpp v200, v200, v200 row_shr:4 row_mask:0xf bank_mask:0xf bound_ctrl:0
    v_add_f32_dpp v201, v201, v201 row_shr:4 row_mask:0xf bank_mask:0xf bound_ctrl:0
    s_nop 0
    v_add_f32_dpp v200, v200, v200 row_shr:8 row_mask:0xf bank_mask:0xf bound_ctrl:0
    v_add_f32_dpp v201, v201, v201 row_shr:8 row_mask:0xf bank_mask:0xf bound_ctrl:0
    s_nop 0
    v_add_f32_dpp v200, v200, v200 row_bcast:15 row_mask:0xa bank_mask:0xf
    v_add_f32_dpp v201, v201, v201 row_bcast:15 row_mask:0xa bank_mask:0xf
    s_nop 0
    v_add_f32_dpp v200, v200, v200 row_bcast:31 row_mask:0xc bank_mask:0xf
    v_add_f32_dpp v201, v201, v201 row_bcast:31 row_mask:0xc bank_mask:0xf
    s_nop 1
    v_readlane_b32 s8, v200, 63
    v_readlane_b32 s9, v201, 63
    v_mov_b32 v202, 0x3b000000
    v_mov_b32 v214, 0xbfb8aa3b
    v_mul_f32 v202, s8, v202
    v_mul_f32 v214, s9, v214
    v_sub_f32 v184, v184, v202
    v_sub_f32 v185, v185, v202
    v_sub_f32 v186, v186, v202
    v_sub_f32 v187, v187, v202
    v_sub_f32 v188, v188, v202
    v_sub_f32 v189, v189, v202
    v_sub_f32 v190, v190, v202
    v_sub_f32 v191, v191, v202
    v_exp_f32 v214, v214
    v_mul_f32 v200, v184, v184
    v_fmac_f32 v200, v185, v185
    v_fmac_f32 v200, v186, v186
    v_fmac_f32 v200, v187, v187
    v_fmac_f32 v200, v188, v188
    v_fmac_f32 v200, v189, v189
    v_fmac_f32 v200, v190, v190
    v_fmac_f32 v200, v191, v191
    s_nop 1
    v_add_f32_dpp v200, v200, v200 row_shr:1 row_mask:0xf bank_mask:0xf bound_ctrl:0
    s_nop 1
    v_add_f32_dpp v200, v200, v200 row_shr:2 row_mask:0xf bank_mask:0xf bound_ctrl:0
    s_nop 1
    v_add_f32_dpp v200, v200, v200 row_shr:4 row_mask:0xf bank_mask:0xf bound_ctrl:0
    s_nop 1
    v_add_f32_dpp v200, v200, v200 row_shr:8 row_mask:0xf bank_mask:0xf bound_ctrl:0
    s_nop 1
    v_add_f32_dpp v200, v200, v200 row_bcast:15 row_mask:0xa bank_mask:0xf
    s_nop 1
    v_add_f32_dpp v200, v200, v200 row_bcast:31 row_mask:0xc bank_mask:0xf
    s_nop 1
    v_readlane_b32 s8, v200, 63
    v_add_f32 v214, 1.0, v214
    v_mov_b32 v202, 0x3b000000
    v_mov_b32 v203, 0x3727c5ac
    v_fma_f32 v202, s8, v202, v203
    v_rsq_f32 v202, v202
    v_rcp_f32 v214, v214
    v_mul_f32 v184, v184, v202
    v_mul_f32 v185, v185, v202
    v_mul_f32 v186, v186, v202
    v_mul_f32 v187, v187, v202
    v_mul_f32 v188, v188, v202
    v_mul_f32 v189, v189, v202
    v_mul_f32 v190, v190, v202
    v_mul_f32 v191, v191, v202
    v_cvt_pk_bf16_f32 v192, v184, v185
    v_cvt_pk_bf16_f32 v193, v186, v187
    v_cvt_pk_bf16_f32 v194, v188, v189
    v_cvt_pk_bf16_f32 v195, v190, v191
    v_mul_u32_u24 v204, 144, v0
    s_lshl_b32 s8, s3, 1
    s_add_u32 s8, s8, 114688
    v_add_u32 v204, s8, v204
    ds_write_b16 v204, v192 offset:0
    ds_write_b16_d16_hi v204, v192 offset:16
    ds_write_b16 v204, v193 offset:32
    ds_write_b16_d16_hi v204, v193 offset:48
    ds_write_b16 v204, v194 offset:64
    ds_write_b16_d16_hi v204, v194 offset:80
    ds_write_b16 v204, v195 offset:96
    ds_write_b16_d16_hi v204, v195 offset:112
    v_bfe_u32 v205, v0, 2, 1
    v_bfe_u32 v206, v0, 3, 1
    v_lshrrev_b32 v207, 4, v0
    v_lshl_add_u32 v207, v207, 1, v205
    v_mul_u32_u24 v204, 144, v207
    v_and_b32 v207, 3, v0
    v_lshl_add_u32 v207, v206, 2, v207
    v_lshl_add_u32 v204, v207, 4, v204
    s_mul_i32 s8, s3, 1152
    s_add_u32 s8, s8, 114688
    v_add_u32 v204, s8, v204
    v_lshrrev_b32 v205, 5, v0
    v_lshlrev_b32 v205, 10, v205
    v_and_b32 v210, 31, v0
    v_lshl_add_u32 v205, v210, 4, v205
    s_lshl_b32 s10, s3, 18
    s_lshr_b32 s9, s80, 4
    s_lshl_b32 s9, s9, 11
    s_add_u32 s10, s10, s9
    s_and_b32 s9, s80, 8
    s_lshl_b32 s9, s9, 6
    s_add_u32 s10, s10, s9
    s_add_u32 s11, s80, s3
    s_lshl_b32 s11, s11, 2
    s_add_u32 s11, s11, 12582912
    v_mov_b32 v210, 0
    s_waitcnt lgkmcnt(0)
    v_mfma_f32_32x32x16_bf16 v[80:95], v[32:35], v[16:19], v[80:95]
    s_waitcnt vmcnt(3)
    s_barrier
    ds_read_b128 v[112:115], v160 offset:32768
    ds_read_b64_tr_b16 v[128:129], v164 offset:25600
    ds_read_b64_tr_b16 v[130:131], v164 offset:25856
    ds_read_b64_tr_b16 v[132:133], v164 offset:26624
    v_mfma_f32_32x32x16_bf16 v[96:111], v[16:19], v[36:39], v[96:111]
    ds_read_b64_tr_b16 v[134:135], v164 offset:26880
    ds_read_b128 v[116:119], v161 offset:32768
    ds_read_b64_tr_b16 v[136:137], v164 offset:28672
    ds_read_b64_tr_b16 v[138:139], v164 offset:28928
    v_mfma_f32_32x32x16_bf16 v[80:95], v[40:43], v[20:23], v[80:95]
    ds_read_b64_tr_b16 v[140:141], v164 offset:29696
    ds_read_b64_tr_b16 v[142:143], v164 offset:29952
    ds_read_b128 v[120:123], v162 offset:32768
    ds_read_b64_tr_b16 v[144:145], v164 offset:31744
    v_mfma_f32_32x32x16_bf16 v[96:111], v[20:23], v[44:47], v[96:111]
    ds_read_b64_tr_b16 v[146:147], v164 offset:32000
    ds_read_b64_tr_b16 v[148:149], v164 offset:32768
    ds_read_b64_tr_b16 v[150:151], v164 offset:33024
    ds_read_b128 v[124:127], v163 offset:32768
    v_mfma_f32_32x32x16_bf16 v[80:95], v[48:51], v[24:27], v[80:95]
    ds_read_b64_tr_b16 v[152:153], v164 offset:34816
    ds_read_b64_tr_b16 v[154:155], v164 offset:35072
    ds_read_b64_tr_b16 v[156:157], v164 offset:35840
    ds_read_b64_tr_b16 v[158:159], v164 offset:36096
    v_mfma_f32_32x32x16_bf16 v[96:111], v[24:27], v[52:55], v[96:111]
    v_mfma_f32_32x32x16_bf16 v[80:95], v[56:59], v[28:31], v[80:95]
    v_mfma_f32_32x32x16_bf16 v[96:111], v[28:31], v[60:63], v[96:111]
    ds_read_b128 v[206:209], v204
    s_waitcnt lgkmcnt(0)
    buffer_store_dwordx4 v[206:209], v205, s[60:63], s10 offen sc1
    s_mov_b64 exec, 1
    buffer_store_dword v214, v210, s[60:63], s11 offen sc1
    s_mov_b64 exec, -1
    buffer_load_dwordx2 v[216:217], v210, s[92:95], 0 offen sc1
    s_and_b32 s8, s85, 7
    s_add_u32 s85, s85, 1
    s_mul_i32 s8, s8, s86
    s_add_u32 m0, s83, 0
    s_add_u32 s8, s8, s82
    buffer_load_dwordx4 v166, s[44:47], s8 offen offset:0 lds
    buffer_load_dwordx4 v167, s[44:47], s8 offen offset:1024 lds
    buffer_load_dwordx4 v168, s[44:47], s8 offen offset:2048 lds
    s_mov_b32 s52, s24
    s_mov_b32 s53, s25
    s_mov_b32 s54, 0x700000
    s_mov_b32 s55, 0x00020000
    v_lshrrev_b32 v174, 5, v0
    v_mul_u32_u24 v174, 3584, v174
    v_and_b32 v175, 31, v0
    v_lshl_add_u32 v174, v175, 4, v174
    s_lshr_b32 s8, s4, 1
    s_mul_i32 s8, s8, 7
    s_and_b32 s9, s4, 1
    s_mul_i32 s9, s9, 3
    s_add_u32 s8, s8, s9
    s_lshl_b32 s90, s8, 7
    s_lshl_b32 s8, s5, 3
    s_add_u32 s8, s8, s3
    s_lshr_b32 s9, s8, 6
    s_lshl_b32 s9, s9, 9
    s_and_b32 s8, s8, 63
    s_lshl_b32 s8, s8, 1
    s_add_u32 s8, s8, s9
    s_mul_i32 s8, s8, 3584
    s_add_u32 s8, s8, s90
    s_mov_b32 s87, s8
    s_lshl_b32 s84, s7, 2
    s_add_u32 s84, s84, s81
    v_lshlrev_b32 v170, 4, v0
    s_lshl_b32 s88, s6, 18
    s_lshl_b32 s9, s84, 11
    s_add_u32 s88, s88, s9
    s_add_u32 s88, s88, 2097152
    s_add_u32 s89, s88, 0x20000
    v_lshrrev_b32 v171, 5, v0
    v_lshlrev_b32 v171, 8, v171
    v_and_b32 v172, 15, v0
    v_lshl_add_u32 v171, v172, 4, v171
    v_bfe_u32 v173, v0, 4, 1
    v_lshl_add_u32 v172, v173, 17, v171
    s_and_b32 s8, s81, 1
    s_mul_i32 s8, s8, 2080
    s_lshr_b32 s9, s81, 1
    s_mul_i32 s9, s9, 8320
    s_add_u32 s8, s8, s9
    s_add_u32 s8, s8, 131584
    v_mul_u32_u24 v173, 4160, v173
    v_add3_u32 v173, v173, v171, s8
    v_add_u32 v171, s8, v170
    s_waitcnt lgkmcnt(0)
    v_mfma_f32_32x32x16_bf16 v[80:95], v[128:131], v[112:115], v[80:95]
    s_waitcnt vmcnt(6)
    s_barrier
    ds_read_b128 v[16:19], v160 offset:49152
    ds_read_b64_tr_b16 v[32:33], v164 offset:37888
    ds_read_b64_tr_b16 v[34:35], v164 offset:38144
    ds_read_b64_tr_b16 v[36:37], v164 offset:38912
    v_mfma_f32_32x32x16_bf16 v[96:111], v[112:115], v[132:135], v[96:111]
    ds_read_b64_tr_b16 v[38:39], v164 offset:39168
    ds_read_b128 v[20:23], v161 offset:49152
    ds_read_b64_tr_b16 v[40:41], v164 offset:40960
    ds_read_b64_tr_b16 v[42:43], v164 offset:41216
    v_mfma_f32_32x32x16_bf16 v[80:95], v[136:139], v[116:119], v[80:95]
    ds_read_b64_tr_b16 v[44:45], v164 offset:41984
    ds_read_b64_tr_b16 v[46:47], v164 offset:42240
    ds_read_b128 v[24:27], v162 offset:49152
    ds_read_b64_tr_b16 v[48:49], v164 offset:44032
    v_mfma_f32_32x32x16_bf16 v[96:111], v[116:119], v[140:143], v[96:111]
    ds_read_b64_tr_b16 v[50:51], v164 offset:44288
    ds_read_b64_tr_b16 v[52:53], v164 offset:45056
    ds_read_b64_tr_b16 v[54:55], v164 offset:45312
    ds_read_b128 v[28:31], v163 offset:49152
    v_mfma_f32_32x32x16_bf16 v[80:95], v[144:147], v[120:123], v[80:95]
    ds_read_b64_tr_b16 v[56:57], v164 offset:47104
    ds_read_b64_tr_b16 v[58:59], v164 offset:47360
    ds_read_b64_tr_b16 v[60:61], v164 offset:48128
    ds_read_b64_tr_b16 v[62:63], v164 offset:48384
    v_mfma_f32_32x32x16_bf16 v[96:111], v[120:123], v[148:151], v[96:111]
    v_mfma_f32_32x32x16_bf16 v[80:95], v[152:155], v[124:127], v[80:95]
    v_mfma_f32_32x32x16_bf16 v[96:111], v[124:127], v[156:159], v[96:111]
    s_and_b32 s8, s85, 7
    s_add_u32 s85, s85, 1
    s_mul_i32 s8, s8, s86
    s_add_u32 m0, s83, 12288
    s_add_u32 s8, s8, s82
    buffer_load_dwordx4 v166, s[44:47], s8 offen offset:0 lds
    buffer_load_dwordx4 v167, s[44:47], s8 offen offset:1024 lds
    buffer_load_dwordx4 v168, s[44:47], s8 offen offset:2048 lds
    s_mov_b32 s48, s20
    s_mov_b32 s49, s21
    s_mov_b32 s50, 0x80000
    s_mov_b32 s51, 0x00020000
    s_mov_b32 s68, s26
    s_mov_b32 s69, s27
    s_mov_b32 s70, 0xe00
    s_mov_b32 s71, 0x00020000
    s_mov_b32 s56, s28
    s_mov_b32 s57, s29
    s_mov_b32 s58, 0x700000
    s_mov_b32 s59, 0x00020000
    s_mov_b32 s72, s30
    s_mov_b32 s73, s31
    s_mov_b32 s74, 0x1000
    s_mov_b32 s75, 0x00020000
    s_mov_b32 s64, s34
    s_mov_b32 s65, s35
    s_mov_b32 s66, 0x200000
    s_mov_b32 s67, 0x00020000
    v_lshrrev_b32 v64, 3, v0
    v_and_b32 v65, 7, v0
    v_bfe_u32 v66, v0, 4, 1
    v_lshlrev_b32 v66, 2, v66
    v_xor_b32 v65, v65, v66
    v_lshlrev_b32 v65, 4, v65
    v_mul_u32_u24 v2, 3584, v64
    v_add_u32 v2, v2, v65
    v_lshl_add_u32 v3, v64, 12, v65
    v_lshl_add_u32 v4, v64, 10, v65
    s_mul_i32 s18, s81, 12288
    s_add_u32 s18, s18, 0
    v_bfe_u32 v64, v0, 2, 2
    v_lshlrev_b32 v65, 7, v64
    v_bfe_u32 v64, v0, 3, 1
    v_lshl_add_u32 v65, v64, 6, v65
    v_bfe_u32 v64, v0, 4, 1
    v_lshl_add_u32 v65, v64, 5, v65
    v_add_u32 v65, s18, v65
    v_and_b32 v64, 3, v0
    v_lshl_add_u32 v66, v64, 3, v65
    v_and_b32 v64, 1, v0
    v_lshl_add_u32 v67, v64, 4, v65
    v_bfe_u32 v64, v0, 1, 1
    v_lshl_add_u32 v67, v64, 3, v67
    v_lshrrev_b32 v64, 5, v0
    s_lshr_b32 s8, s81, 1
    s_and_b32 s9, s81, 1
    s_lshl_b32 s19, s8, 6
    s_lshl_b32 s20, s9, 6
    v_lshl_add_u32 v5, v64, 10, v66
    v_xor_b32 v5, s19, v5
    v_xor_b32 v6, 64, v5
    v_lshl_add_u32 v7, v64, 9, v66
    v_xor_b32 v7, s20, v7
    v_xor_b32 v8, 64, v7
    v_lshl_add_u32 v9, v64, 9, v67
    v_xor_b32 v9, s19, v9
    v_xor_b32 v10, 64, v9
    s_lshl_b32 s19, s8, 10
    s_lshl_b32 s20, s9, 10
    v_lshlrev_b32 v64, 4, v0
    v_add_u32 v11, s20, v64
    v_xor_b32 v12, 1024, v11
    v_add_u32 v13, s19, v64
    v_xor_b32 v14, 1024, v13
    s_xor_b32 s8, s81, 1
    s_mul_i32 s8, s8, 12288
    s_add_u32 s8, s8, 0
    v_add_u32 v241, s8, v64
    s_xor_b32 s8, s81, 2
    s_mul_i32 s8, s8, 12288
    s_add_u32 s8, s8, 4096
    v_add_u32 v242, s8, v64
    s_xor_b32 s8, s81, 3
    s_mul_i32 s8, s8, 12288
    s_add_u32 s8, s8, 8192
    v_add_u32 v243, s8, v64
    s_mul_i32 s8, s81, 12288
    s_add_u32 s8, s8, 0
    v_add_u32 v240, s8, v64
    s_lshr_b32 s8, s4, 1
    s_mul_i32 s8, s8, 7
    s_and_b32 s9, s4, 1
    s_lshl_b32 s9, s9, 2
    s_lshr_b32 s23, s5, 3
    s_add_u32 s20, s8, s9
    s_add_u32 s20, s20, s23
    s_add_u32 s8, s8, 3
    s_and_b32 s19, s5, 7
    s_and_b32 s21, s5, 3
    s_add_u32 s9, s9, s21
    s_cmp_eq_u32 s23, 3
    s_cselect_b32 s20, s8, s20
    s_cselect_b32 s19, s9, s19
    s_and_b32 s23, s23, 0
    s_lshl_b32 s23, s23, 4
    s_lshr_b32 s22, s5, 2
    s_and_b32 s9, s21, 0
    s_mul_i32 s9, s9, 14
    s_lshl_b32 s8, s4, 2
    s_add_u32 s21, s8, s21
    s_mul_i32 s8, s22, 7
    s_lshr_b32 s8, s8, 1
    s_add_u32 s24, s9, s8
    s_sub_u32 s9, s24, 28
    s_cmp_ge_u32 s24, 28
    s_cselect_b32 s24, s9, s24
    s_waitcnt lgkmcnt(0)
    v_mfma_f32_32x32x16_bf16 v[80:95], v[32:35], v[16:19], v[80:95]
    s_waitcnt vmcnt(3)
    s_barrier
    ds_read_b128 v[112:115], v160 offset:0
    ds_read_b64_tr_b16 v[128:129], v164 offset:1024
    ds_read_b64_tr_b16 v[130:131], v164 offset:1280
    ds_read_b64_tr_b16 v[132:133], v164 offset:2048
    v_mfma_f32_32x32x16_bf16 v[96:111], v[16:19], v[36:39], v[96:111]
    ds_read_b64_tr_b16 v[134:135], v164 offset:2304
    ds_read_b128 v[116:119], v161 offset:0
    ds_read_b64_tr_b16 v[136:137], v164 offset:4096
    ds_read_b64_tr_b16 v[138:139], v164 offset:4352
    v_mfma_f32_32x32x16_bf16 v[80:95], v[40:43], v[20:23], v[80:95]
    ds_read_b64_tr_b16 v[140:141], v164 offset:5120
    ds_read_b64_tr_b16 v[142:143], v164 offset:5376
    ds_read_b128 v[120:123], v162 offset:0
    ds_read_b64_tr_b16 v[144:145], v164 offset:7168
    v_mfma_f32_32x32x16_bf16 v[96:111], v[20:23], v[44:47], v[96:111]
    ds_read_b64_tr_b16 v[146:147], v164 offset:7424
    ds_read_b64_tr_b16 v[148:149], v164 offset:8192
    ds_read_b64_tr_b16 v[150:151], v164 offset:8448
    ds_read_b128 v[124:127], v163 offset:0
    v_mfma_f32_32x32x16_bf16 v[80:95], v[48:51], v[24:27], v[80:95]
    ds_read_b64_tr_b16 v[152:153], v164 offset:10240
    ds_read_b64_tr_b16 v[154:155], v164 offset:10496
    ds_read_b64_tr_b16 v[156:157], v164 offset:11264
    ds_read_b64_tr_b16 v[158:159], v164 offset:11520
    v_mfma_f32_32x32x16_bf16 v[96:111], v[24:27], v[52:55], v[96:111]
    v_mfma_f32_32x32x16_bf16 v[80:95], v[56:59], v[28:31], v[80:95]
    v_mfma_f32_32x32x16_bf16 v[96:111], v[28:31], v[60:63], v[96:111]
    s_and_b32 s8, s85, 7
    s_add_u32 s85, s85, 1
    s_mul_i32 s8, s8, s86
    s_add_u32 m0, s83, 24576
    s_add_u32 s8, s8, s82
    buffer_load_dwordx4 v166, s[44:47], s8 offen offset:0 lds
    buffer_load_dwordx4 v167, s[44:47], s8 offen offset:1024 lds
    buffer_load_dwordx4 v168, s[44:47], s8 offen offset:2048 lds
    s_mov_b32 s17, 200000
L_tagl_34:
    v_readfirstlane_b32 s14, v216
    v_readfirstlane_b32 s15, v217
    s_cmp_lg_u32 s14, 0
    s_cbranch_scc1 L_tagok_35
    buffer_load_dwordx2 v[216:217], v210, s[92:95], 0 offen sc1
    s_waitcnt vmcnt(0)
    s_sub_u32 s17, s17, 1
    s_cmp_lg_u32 s17, 0
    s_cbranch_scc1 L_tagl_34
    s_endpgm
L_tagok_35:
    s_getreg_b32 s8, hwreg(HW_REG_XCC_ID)
    s_and_b32 s8, s8, 15
    s_add_u32 s8, s8, 1
    s_lshl_b32 s8, s8, 24
    s_mov_b32 s76, s14
    s_xor_b32 s77, s15, s8
    s_cmp_lg_u32 s81, 0
    s_cbranch_scc1 L_nofh_36
    s_add_u32 s8, s80, 12648448
    v_mov_b32 v220, s14
    v_mov_b32 v221, s15
    v_mov_b32 v218, 0
    s_mov_b64 exec, 1
    buffer_store_dwordx2 v[220:221], v218, s[60:63], s8 offen sc1
    s_mov_b64 exec, -1
L_nofh_36:
    v_lshrrev_b32 v64, 5, v0
    v_lshlrev_b32 v64, 3, v64
    s_lshl_b32 s8, s20, 7
    s_lshr_b32 s9, s81, 1
    s_lshl_b32 s9, s9, 6
    s_add_u32 s8, s8, s9
    buffer_load_dwordx2 v[224:225], v64, s[68:71], s8 offen offset:0
    buffer_load_dwordx2 v[226:227], v64, s[68:71], s8 offen offset:16
    buffer_load_dwordx2 v[228:229], v64, s[68:71], s8 offen offset:32
    buffer_load_dwordx2 v[230:231], v64, s[68:71], s8 offen offset:48
    v_and_b32 v65, 31, v0
    v_lshlrev_b32 v65, 1, v65
    s_lshl_b32 s8, s21, 6
    s_and_b32 s9, s81, 1
    s_lshl_b32 s9, s9, 5
    s_add_u32 s91, s8, s9
    s_lshl_b32 s8, s91, 1
    buffer_load_ushort v15, v65, s[72:75], s8 offen
    v_lshlrev_b32 v244, 3, v0
    s_lshl_b32 s96, s81, 9
    s_add_u32 s96, s96, 12648448
    s_waitcnt lgkmcnt(0)
    v_mfma_f32_32x32x16_bf16 v[80:95], v[128:131], v[112:115], v[80:95]
    s_waitcnt vmcnt(8)
    s_barrier
    ds_read_b128 v[16:19], v160 offset:16384
    ds_read_b64_tr_b16 v[32:33], v164 offset:13312
    ds_read_b64_tr_b16 v[34:35], v164 offset:13568
    ds_read_b64_tr_b16 v[36:37], v164 offset:14336
    v_mfma_f32_32x32x16_bf16 v[96:111], v[112:115], v[132:135], v[96:111]
    ds_read_b64_tr_b16 v[38:39], v164 offset:14592
    ds_read_b128 v[20:23], v161 offset:16384
    ds_read_b64_tr_b16 v[40:41], v164 offset:16384
    ds_read_b64_tr_b16 v[42:43], v164 offset:16640
    v_mfma_f32_32x32x16_bf16 v[80:95], v[136:139], v[116:119], v[80:95]
    ds_read_b64_tr_b16 v[44:45], v164 offset:17408
    ds_read_b64_tr_b16 v[46:47], v164 offset:17664
    ds_read_b128 v[24:27], v162 offset:16384
    ds_read_b64_tr_b16 v[48:49], v164 offset:19456
    v_mfma_f32_32x32x16_bf16 v[96:111], v[116:119], v[140:143], v[96:111]
    ds_read_b64_tr_b16 v[50:51], v164 offset:19712
    ds_read_b64_tr_b16 v[52:53], v164 offset:20480
    ds_read_b64_tr_b16 v[54:55], v164 offset:20736
    ds_read_b128 v[28:31], v163 offset:16384
    v_mfma_f32_32x32x16_bf16 v[80:95], v[144:147], v[120:123], v[80:95]
    ds_read_b64_tr_b16 v[56:57], v164 offset:22528
    ds_read_b64_tr_b16 v[58:59], v164 offset:22784
    ds_read_b64_tr_b16 v[60:61], v164 offset:23552
    ds_read_b64_tr_b16 v[62:63], v164 offset:23808
    v_mfma_f32_32x32x16_bf16 v[96:111], v[120:123], v[148:151], v[96:111]
    v_mfma_f32_32x32x16_bf16 v[80:95], v[152:155], v[124:127], v[80:95]
    v_mfma_f32_32x32x16_bf16 v[96:111], v[124:127], v[156:159], v[96:111]
    s_and_b32 s8, s85, 7
    s_add_u32 s85, s85, 1
    s_mul_i32 s8, s8, s86
    s_add_u32 m0, s83, 36864
    s_add_u32 s8, s8, s82
    buffer_load_dwordx4 v166, s[44:47], s8 offen offset:0 lds
    buffer_load_dwordx4 v167, s[44:47], s8 offen offset:1024 lds
    buffer_load_dwordx4 v168, s[44:47], s8 offen offset:2048 lds
    s_waitcnt lgkmcnt(0)
    v_mfma_f32_32x32x16_bf16 v[80:95], v[32:35], v[16:19], v[80:95]
    s_waitcnt vmcnt(8)
    s_barrier
    ds_read_b128 v[112:115], v160 offset:32768
    ds_read_b64_tr_b16 v[128:129], v164 offset:25600
    ds_read_b64_tr_b16 v[130:131], v164 offset:25856
    ds_read_b64_tr_b16 v[132:133], v164 offset:26624
    v_mfma_f32_32x32x16_bf16 v[96:111], v[16:19], v[36:39], v[96:111]
    ds_read_b64_tr_b16 v[134:135], v164 offset:26880
    ds_read_b128 v[116:119], v161 offset:32768
    ds_read_b64_tr_b16 v[136:137], v164 offset:28672
    ds_read_b64_tr_b16 v[138:139], v164 offset:28928
    v_mfma_f32_32x32x16_bf16 v[80:95], v[40:43], v[20:23], v[80:95]
    ds_read_b64_tr_b16 v[140:141], v164 offset:29696
    ds_read_b64_tr_b16 v[142:143], v164 offset:29952
    ds_read_b128 v[120:123], v162 offset:32768
    ds_read_b64_tr_b16 v[144:145], v164 offset:31744
    v_mfma_f32_32x32x16_bf16 v[96:111], v[20:23], v[44:47], v[96:111]
    ds_read_b64_tr_b16 v[146:147], v164 offset:32000
    ds_read_b64_tr_b16 v[148:149], v164 offset:32768
    ds_read_b64_tr_b16 v[150:151], v164 offset:33024
    ds_read_b128 v[124:127], v163 offset:32768
    v_mfma_f32_32x32x16_bf16 v[80:95], v[48:51], v[24:27], v[80:95]
    ds_read_b64_tr_b16 v[152:153], v164 offset:34816
    ds_read_b64_tr_b16 v[154:155], v164 offset:35072
    ds_read_b64_tr_b16 v[156:157], v164 offset:35840
    ds_read_b64_tr_b16 v[158:159], v164 offset:36096
    v_mfma_f32_32x32x16_bf16 v[96:111], v[24:27], v[52:55], v[96:111]
    v_mfma_f32_32x32x16_bf16 v[80:95], v[56:59], v[28:31], v[80:95]
    v_mfma_f32_32x32x16_bf16 v[96:111], v[28:31], v[60:63], v[96:111]
    buffer_load_dwordx4 v[248:251], v170, s[60:63], s88 offen nt
    buffer_load_dwordx4 v[248:251], v170, s[60:63], s89 offen nt
    s_add_u32 s8, s87, 0
    buffer_load_dwordx4 v[248:251], v174, s[52:55], s8 offen
    s_waitcnt lgkmcnt(0)
    v_mfma_f32_32x32x16_bf16 v[80:95], v[128:131], v[112:115], v[80:95]
    s_waitcnt vmcnt(3)
    s_barrier
    ds_read_b128 v[16:19], v160 offset:49152
    ds_read_b64_tr_b16 v[32:33], v164 offset:37888
    ds_read_b64_tr_b16 v[34:35], v164 offset:38144
    ds_read_b64_tr_b16 v[36:37], v164 offset:38912
    v_mfma_f32_32x32x16_bf16 v[96:111], v[112:115], v[132:135], v[96:111]
    ds_read_b64_tr_b16 v[38:39], v164 offset:39168
    ds_read_b128 v[20:23], v161 offset:49152
    ds_read_b64_tr_b16 v[40:41], v164 offset:40960
    ds_read_b64_tr_b16 v[42:43], v164 offset:41216
    v_mfma_f32_32x32x16_bf16 v[80:95], v[136:139], v[116:119], v[80:95]
    ds_read_b64_tr_b16 v[44:45], v164 offset:41984
    ds_read_b64_tr_b16 v[46:47], v164 offset:42240
    ds_read_b128 v[24:27], v162 offset:49152
    ds_read_b64_tr_b16 v[48:49], v164 offset:44032
    v_mfma_f32_32x32x16_bf16 v[96:111], v[116:119], v[140:143], v[96:111]
    ds_read_b64_tr_b16 v[50:51], v164 offset:44288
    ds_read_b64_tr_b16 v[52:53], v164 offset:45056
    ds_read_b64_tr_b16 v[54:55], v164 offset:45312
    ds_read_b128 v[28:31], v163 offset:49152
    v_mfma_f32_32x32x16_bf16 v[80:95], v[144:147], v[120:123], v[80:95]
    ds_read_b64_tr_b16 v[56:57], v164 offset:47104
    ds_read_b64_tr_b16 v[58:59], v164 offset:47360
    ds_read_b64_tr_b16 v[60:61], v164 offset:48128
    ds_read_b64_tr_b16 v[62:63], v164 offset:48384
    v_mfma_f32_32x32x16_bf16 v[96:111], v[120:123], v[148:151], v[96:111]
    v_mfma_f32_32x32x16_bf16 v[80:95], v[152:155], v[124:127], v[80:95]
    v_mfma_f32_32x32x16_bf16 v[96:111], v[124:127], v[156:159], v[96:111]
    s_waitcnt lgkmcnt(0)
    v_mfma_f32_32x32x16_bf16 v[80:95], v[32:35], v[16:19], v[80:95]
    v_mfma_f32_32x32x16_bf16 v[96:111], v[16:19], v[36:39], v[96:111]
    v_mfma_f32_32x32x16_bf16 v[80:95], v[40:43], v[20:23], v[80:95]
    v_mfma_f32_32x32x16_bf16 v[96:111], v[20:23], v[44:47], v[96:111]
    v_mfma_f32_32x32x16_bf16 v[80:95], v[48:51], v[24:27], v[80:95]
    v_mfma_f32_32x32x16_bf16 v[96:111], v[24:27], v[52:55], v[96:111]
    v_mfma_f32_32x32x16_bf16 v[80:95], v[56:59], v[28:31], v[80:95]
    v_mfma_f32_32x32x16_bf16 v[96:111], v[28:31], v[60:63], v[96:111]
    s_nop 10
    v_cvt_pk_bf16_f32 v112, v80, v81
    v_cvt_pk_bf16_f32 v113, v82, v83
    v_cvt_pk_bf16_f32 v114, v84, v85
    v_cvt_pk_bf16_f32 v115, v86, v87
    v_cvt_pk_bf16_f32 v116, v88, v89
    v_cvt_pk_bf16_f32 v117, v90, v91
    v_cvt_pk_bf16_f32 v118, v92, v93
    v_cvt_pk_bf16_f32 v119, v94, v95
    v_cvt_pk_bf16_f32 v120, v96, v97
    v_cvt_pk_bf16_f32 v121, v98, v99
    v_cvt_pk_bf16_f32 v122, v100, v101
    v_cvt_pk_bf16_f32 v123, v102, v103
    v_cvt_pk_bf16_f32 v124, v104, v105
    v_cvt_pk_bf16_f32 v125, v106, v107
    v_cvt_pk_bf16_f32 v126, v108, v109
    v_cvt_pk_bf16_f32 v127, v110, v111
    ds_write_b128 v171, v[112:115]
    ds_write_b128 v171, v[116:119] offset:4160
    s_cmp_lg_u32 s81, 0
    s_cbranch_scc1 L_nok0_37
    ds_write_b128 v171, v[112:115] offset:25088
    ds_write_b128 v171, v[116:119] offset:26112
L_nok0_37:
    ds_write_b128 v173, v[120:123] offset:1024
    ds_write_b128 v173, v[124:127] offset:1536
    s_waitcnt lgkmcnt(0)
    s_barrier
    buffer_store_dwordx4 v[112:115], v170, s[60:63], s88 offen
    buffer_store_dwordx4 v[116:119], v170, s[60:63], s89 offen
    buffer_store_dwordx4 v[120:123], v172, s[60:63], s88 offen offset:1024
    buffer_store_dwordx4 v[124:127], v172, s[60:63], s88 offen offset:1536
    buffer_load_dwordx2 v[232:233], v244, s[60:63], s96 offen sc1
    v_mov_b32 v1, 1
    v_lshlrev_b32 v16, 16, v224
    v_and_b32 v17, 0xffff0000, v224
    v_lshlrev_b32 v18, 16, v225
    v_and_b32 v19, 0xffff0000, v225
    v_lshlrev_b32 v20, 16, v226
    v_and_b32 v21, 0xffff0000, v226
    v_lshlrev_b32 v22, 16, v227
    v_and_b32 v23, 0xffff0000, v227
    v_lshlrev_b32 v24, 16, v228
    v_and_b32 v25, 0xffff0000, v228
    v_lshlrev_b32 v26, 16, v229
    v_and_b32 v27, 0xffff0000, v229
    v_lshlrev_b32 v28, 16, v230
    v_and_b32 v29, 0xffff0000, v230
    v_lshlrev_b32 v30, 16, v231
    v_and_b32 v31, 0xffff0000, v231
    s_mul_i32 s26, s81, 1835008
    s_lshl_b32 s8, s20, 7
    s_add_u32 s26, s26, s8
    s_add_u32 s27, s26, 1835008
    s_mul_i32 s25, s23, 57344
    s_add_u32 s25, s25, s26
    s_lshl_b32 s29, s19, 18
    s_lshl_b32 s8, s81, 16
    s_add_u32 s29, s29, s8
    s_add_u32 s30, s29, 65536
    s_mul_i32 s28, s23, 2048
    s_add_u32 s28, s28, s29
    s_lshl_b32 s8, s6, 4
    s_add_u32 s8, s8, s7
    s_lshl_b32 s8, s8, 4
    s_add_u32 s8, s8, s81
    s_lshl_b32 s8, s8, 3
    s_add_u32 s8, s8, 12713984
    s_add_u32 s84, s8, 32768
    s_waitcnt vmcnt(1)
    v_mov_b32 v246, s76
    v_mov_b32 v247, s77
    v_mov_b32 v244, 0
    s_mov_b64 exec, 1
    buffer_store_dwordx2 v[246:247], v244, s[60:63], s8 offen
    s_mov_b64 exec, -1
    s_lshl_b32 s31, s81, 17
    s_lshl_b32 s8, s22, 7
    s_add_u32 s31, s31, s8
    s_cmp_ge_u32 s5, 28
    s_cbranch_scc1 L_skipg1_38
    s_add_u32 m0, s18, 0
    s_add_u32 s8, s25, 27648
    buffer_load_dwordx4 v2, s[52:55], s25 offen lds
    buffer_load_dwordx4 v2, s[52:55], s8 offen offset:1024 lds
    s_add_u32 s25, s25, 57344
    s_cmp_eq_u32 s25, s27
    s_cselect_b32 s25, s26, s25
    s_add_u32 m0, s18, 2048
    s_add_u32 s8, s25, 27648
    buffer_load_dwordx4 v2, s[52:55], s25 offen lds
    buffer_load_dwordx4 v2, s[52:55], s8 offen offset:1024 lds
    s_add_u32 s25, s25, 57344
    s_cmp_eq_u32 s25, s27
    s_cselect_b32 s25, s26, s25
    s_add_u32 m0, s18, 4096
    s_add_u32 s8, s25, 27648
    buffer_load_dwordx4 v2, s[52:55], s25 offen lds
    buffer_load_dwordx4 v2, s[52:55], s8 offen offset:1024 lds
    s_add_u32 s25, s25, 57344
    s_cmp_eq_u32 s25, s27
    s_cselect_b32 s25, s26, s25
    s_waitcnt vmcnt(4)
    s_add_u32 m0, s18, 6144
    s_add_u32 s8, s25, 27648
    buffer_load_dwordx4 v2, s[52:55], s25 offen lds
    buffer_load_dwordx4 v2, s[52:55], s8 offen offset:1024 lds
    s_add_u32 s25, s25, 57344
    s_cmp_eq_u32 s25, s27
    s_cselect_b32 s25, s26, s25
    s_waitcnt vmcnt(4)
    s_add_u32 m0, s18, 8192
    s_add_u32 s8, s25, 27648
    buffer_load_dwordx4 v2, s[52:55], s25 offen lds
    buffer_load_dwordx4 v2, s[52:55], s8 offen offset:1024 lds
    s_add_u32 s25, s25, 57344
    s_cmp_eq_u32 s25, s27
    s_cselect_b32 s25, s26, s25
    s_waitcnt vmcnt(4)
    s_add_u32 m0, s18, 10240
    s_add_u32 s8, s25, 27648
    buffer_load_dwordx4 v2, s[52:55], s25 offen lds
    buffer_load_dwordx4 v2, s[52:55], s8 offen offset:1024 lds
    s_add_u32 s25, s25, 57344
    s_cmp_eq_u32 s25, s27
    s_cselect_b32 s25, s26, s25
    s_waitcnt vmcnt(4)
    s_add_u32 m0, s18, 49152
    s_add_u32 s8, s25, 27648
    buffer_load_dwordx4 v2, s[52:55], s25 offen lds
    buffer_load_dwordx4 v2, s[52:55], s8 offen offset:1024 lds
    s_add_u32 s25, s25, 57344
    s_cmp_eq_u32 s25, s27
    s_cselect_b32 s25, s26, s25
    s_waitcnt vmcnt(4)
    s_add_u32 m0, s18, 51200
    s_add_u32 s8, s25, 27648
    buffer_load_dwordx4 v2, s[52:55], s25 offen lds
    buffer_load_dwordx4 v2, s[52:55], s8 offen offset:1024 lds
    s_add_u32 s25, s25, 57344
    s_cmp_eq_u32 s25, s27
    s_cselect_b32 s25, s26, s25
    v_mov_b32 v244, 156452
    s_mov_b32 s17, 24
L_sy_40:
    ds_read_b32 v245, v244
    s_waitcnt lgkmcnt(0)
    v_readfirstlane_b32 s8, v245
    s_cmp_ge_u32 s8, 4
    s_cbranch_scc1 L_syd_41
    s_sleep 1
    s_sub_u32 s17, s17, 1
    s_cmp_lg_u32 s17, 0
    s_cbranch_scc1 L_sy_40
L_syd_41:
    v_cmp_ne_u64 vcc, s[14:15], v[232:233]
    s_and_b32 s10, vcc_lo, -1
    s_and_b32 s11, vcc_hi, -1
    s_or_b32 s10, s10, s11
    s_cmp_eq_u32 s10, 0
    s_cbranch_scc1 L_hok_42
    v_lshlrev_b32 v244, 3, v0
    s_mov_b32 s17, 200000
L_poll_43:
    buffer_load_dwordx2 v[246:247], v244, s[60:63], s96 offen sc1
    s_waitcnt vmcnt(0)
    v_cmp_ne_u64 vcc, s[14:15], v[246:247]
    s_and_b32 s10, vcc_lo, -1
    s_and_b32 s11, vcc_hi, -1
    s_or_b32 s10, s10, s11
    s_cmp_eq_u32 s10, 0
    s_cbranch_scc1 L_pollok_44
    s_sleep 2
    s_sub_u32 s17, s17, 1
    s_cmp_lg_u32 s17, 0
    s_cbranch_scc1 L_poll_43
    s_endpgm
L_pollok_44:
L_hok_42:
    v_mov_b32 v247, 156416
    s_setprio 0
    buffer_load_dwordx4 v[80:83], v11, s[60:63], s28 offen sc1
    buffer_load_dwordx4 v[84:87], v12, s[60:63], s28 offen sc1
    s_add_u32 s28, s28, 2048
    s_cmp_eq_u32 s28, s30
    s_cselect_b32 s28, s29, s28
    buffer_load_dwordx4 v[88:91], v11, s[60:63], s28 offen sc1
    buffer_load_dwordx4 v[92:95], v12, s[60:63], s28 offen sc1
    s_add_u32 s28, s28, 2048
    s_cmp_eq_u32 s28, s30
    s_cselect_b32 s28, s29, s28
    buffer_load_dwordx4 v[96:99], v11, s[60:63], s28 offen sc1
    buffer_load_dwordx4 v[100:103], v12, s[60:63], s28 offen sc1
    s_add_u32 s28, s28, 2048
    s_cmp_eq_u32 s28, s30
    s_cselect_b32 s28, s29, s28
    ds_read_b64_tr_b16 v[208:209], v5 offset:0
    ds_read_b64_tr_b16 v[210:211], v5 offset:512
    ds_read_b64_tr_b16 v[212:213], v6 offset:0
    ds_read_b64_tr_b16 v[214:215], v6 offset:512
    s_waitcnt vmcnt(4)
    s_waitcnt lgkmcnt(0)
    v_mfma_f32_32x32x16_bf16 v[16:31], v[208:211], v[80:83], v[16:31]
    buffer_load_dwordx4 v[104:107], v11, s[60:63], s28 offen sc1
    buffer_load_dwordx4 v[108:111], v12, s[60:63], s28 offen sc1
    s_add_u32 s28, s28, 2048
    s_cmp_eq_u32 s28, s30
    s_cselect_b32 s28, s29, s28
    v_mfma_f32_32x32x16_bf16 v[32:47], v[208:211], v[84:87], 0
    ds_read_b64_tr_b16 v[216:217], v5 offset:2048
    ds_read_b64_tr_b16 v[218:219], v5 offset:2560
    ds_read_b64_tr_b16 v[220:221], v6 offset:2048
    ds_read_b64_tr_b16 v[222:223], v6 offset:2560
    v_mfma_f32_32x32x16_bf16 v[48:63], v[212:215], v[80:83], 0
    v_mfma_f32_32x32x16_bf16 v[64:79], v[212:215], v[84:87], 0
    s_waitcnt vmcnt(4)
    s_waitcnt lgkmcnt(0)
    v_mfma_f32_32x32x16_bf16 v[16:31], v[216:219], v[88:91], v[16:31]
    buffer_load_dwordx4 v[80:83], v11, s[60:63], s28 offen sc1
    buffer_load_dwordx4 v[84:87], v12, s[60:63], s28 offen sc1
    s_add_u32 s28, s28, 2048
    s_cmp_eq_u32 s28, s30
    s_cselect_b32 s28, s29, s28
    v_mfma_f32_32x32x16_bf16 v[32:47], v[216:219], v[92:95], v[32:47]
    ds_read_b64_tr_b16 v[208:209], v5 offset:4096
    ds_read_b64_tr_b16 v[210:211], v5 offset:4608
    ds_read_b64_tr_b16 v[212:213], v6 offset:4096
    ds_read_b64_tr_b16 v[214:215], v6 offset:4608
    v_mfma_f32_32x32x16_bf16 v[48:63], v[220:223], v[88:91], v[48:63]
    v_mfma_f32_32x32x16_bf16 v[64:79], v[220:223], v[92:95], v[64:79]
    s_waitcnt vmcnt(4)
    s_waitcnt lgkmcnt(0)
    v_mfma_f32_32x32x16_bf16 v[16:31], v[208:211], v[96:99], v[16:31]
    buffer_load_dwordx4 v[88:91], v11, s[60:63], s28 offen sc1
    buffer_load_dwordx4 v[92:95], v12, s[60:63], s28 offen sc1
    s_add_u32 s28, s28, 2048
    s_cmp_eq_u32 s28, s30
    s_cselect_b32 s28, s29, s28
    v_mfma_f32_32x32x16_bf16 v[32:47], v[208:211], v[100:103], v[32:47]
    ds_read_b64_tr_b16 v[216:217], v5 offset:6144
    ds_read_b64_tr_b16 v[218:219], v5 offset:6656
    ds_read_b64_tr_b16 v[220:221], v6 offset:6144
    ds_read_b64_tr_b16 v[222:223], v6 offset:6656
    v_mfma_f32_32x32x16_bf16 v[48:63], v[212:215], v[96:99], v[48:63]
    v_mfma_f32_32x32x16_bf16 v[64:79], v[212:215], v[100:103], v[64:79]
    s_waitcnt vmcnt(4)
    s_waitcnt lgkmcnt(0)
    v_mfma_f32_32x32x16_bf16 v[16:31], v[216:219], v[104:107], v[16:31]
    buffer_load_dwordx4 v[96:99], v11, s[60:63], s28 offen sc1
    buffer_load_dwordx4 v[100:103], v12, s[60:63], s28 offen sc1
    s_add_u32 s28, s28, 2048
    s_cmp_eq_u32 s28, s30
    s_cselect_b32 s28, s29, s28
    v_mfma_f32_32x32x16_bf16 v[32:47], v[216:219], v[108:111], v[32:47]
    ds_read_b64_tr_b16 v[208:209], v5 offset:8192
    ds_read_b64_tr_b16 v[210:211], v5 offset:8704
    ds_read_b64_tr_b16 v[212:213], v6 offset:8192
    ds_read_b64_tr_b16 v[214:215], v6 offset:8704
    v_mfma_f32_32x32x16_bf16 v[48:63], v[220:223], v[104:107], v[48:63]
    v_mfma_f32_32x32x16_bf16 v[64:79], v[220:223], v[108:111], v[64:79]
    s_waitcnt vmcnt(4)
    s_waitcnt lgkmcnt(0)
    v_mfma_f32_32x32x16_bf16 v[16:31], v[208:211], v[80:83], v[16:31]
    buffer_load_dwordx4 v[104:107], v11, s[60:63], s28 offen sc1
    buffer_load_dwordx4 v[108:111], v12, s[60:63], s28 offen sc1
    s_add_u32 s28, s28, 2048
    s_cmp_eq_u32 s28, s30
    s_cselect_b32 s28, s29, s28
    v_mfma_f32_32x32x16_bf16 v[32:47], v[208:211], v[84:87], v[32:47]
    ds_read_b64_tr_b16 v[216:217], v5 offset:10240
    ds_read_b64_tr_b16 v[218:219], v5 offset:10752
    ds_read_b64_tr_b16 v[220:221], v6 offset:10240
    ds_read_b64_tr_b16 v[222:223], v6 offset:10752
    v_mfma_f32_32x32x16_bf16 v[48:63], v[212:215], v[80:83], v[48:63]
    v_mfma_f32_32x32x16_bf16 v[64:79], v[212:215], v[84:87], v[64:79]
    s_waitcnt vmcnt(4)
    s_waitcnt lgkmcnt(0)
    v_mfma_f32_32x32x16_bf16 v[16:31], v[216:219], v[88:91], v[16:31]
    s_mov_b64 exec, 1
    ds_add_u32 v247, v1 offset:40
    s_mov_b64 exec, -1
    buffer_load_dwordx4 v[80:83], v11, s[60:63], s28 offen sc1
    buffer_load_dwordx4 v[84:87], v12, s[60:63], s28 offen sc1
    s_add_u32 s28, s28, 2048
    s_cmp_eq_u32 s28, s30
    s_cselect_b32 s28, s29, s28
    v_mfma_f32_32x32x16_bf16 v[32:47], v[216:219], v[92:95], v[32:47]
    ds_read_b64_tr_b16 v[208:209], v5 offset:49152
    ds_read_b64_tr_b16 v[210:211], v5 offset:49664
    ds_read_b64_tr_b16 v[212:213], v6 offset:49152
    ds_read_b64_tr_b16 v[214:215], v6 offset:49664
    v_mfma_f32_32x32x16_bf16 v[48:63], v[220:223], v[88:91], v[48:63]
    s_add_u32 m0, s18, 53248
    s_add_u32 s8, s25, 27648
    buffer_load_dwordx4 v2, s[52:55], s25 offen lds
    buffer_load_dwordx4 v2, s[52:55], s8 offen offset:1024 lds
    s_add_u32 s25, s25, 57344
    s_cmp_eq_u32 s25, s27
    s_cselect_b32 s25, s26, s25
    v_mfma_f32_32x32x16_bf16 v[64:79], v[220:223], v[92:95], v[64:79]
    s_waitcnt vmcnt(6)
    s_waitcnt lgkmcnt(0)
    v_mfma_f32_32x32x16_bf16 v[16:31], v[208:211], v[96:99], v[16:31]
    buffer_load_dwordx4 v[88:91], v11, s[60:63], s28 offen sc1
    buffer_load_dwordx4 v[92:95], v12, s[60:63], s28 offen sc1
    s_add_u32 s28, s28, 2048
    s_cmp_eq_u32 s28, s30
    s_cselect_b32 s28, s29, s28
    v_mfma_f32_32x32x16_bf16 v[32:47], v[208:211], v[100:103], v[32:47]
    ds_read_b64_tr_b16 v[216:217], v5 offset:51200
    ds_read_b64_tr_b16 v[218:219], v5 offset:51712
    ds_read_b64_tr_b16 v[220:221], v6 offset:51200
    ds_read_b64_tr_b16 v[222:223], v6 offset:51712
    v_mfma_f32_32x32x16_bf16 v[48:63], v[212:215], v[96:99], v[48:63]
    s_add_u32 m0, s18, 55296
    s_add_u32 s8, s25, 27648
    buffer_load_dwordx4 v2, s[52:55], s25 offen lds
    buffer_load_dwordx4 v2, s[52:55], s8 offen offset:1024 lds
    s_add_u32 s25, s25, 57344
    s_cmp_eq_u32 s25, s27
    s_cselect_b32 s25, s26, s25
    v_mfma_f32_32x32x16_bf16 v[64:79], v[212:215], v[100:103], v[64:79]
    s_waitcnt vmcnt(8)
    s_waitcnt lgkmcnt(0)
    v_mfma_f32_32x32x16_bf16 v[16:31], v[216:219], v[104:107], v[16:31]
    buffer_load_dwordx4 v[96:99], v11, s[60:63], s28 offen sc1
    buffer_load_dwordx4 v[100:103], v12, s[60:63], s28 offen sc1
    s_add_u32 s28, s28, 2048
    s_cmp_eq_u32 s28, s30
    s_cselect_b32 s28, s29, s28
    v_mfma_f32_32x32x16_bf16 v[32:47], v[216:219], v[108:111], v[32:47]
    s_waitcnt vmcnt(6)
    ds_read_b64_tr_b16 v[208:209], v5 offset:53248
    ds_read_b64_tr_b16 v[210:211], v5 offset:53760
    ds_read_b64_tr_b16 v[212:213], v6 offset:53248
    ds_read_b64_tr_b16 v[214:215], v6 offset:53760
    v_mfma_f32_32x32x16_bf16 v[48:63], v[220:223], v[104:107], v[48:63]
    s_add_u32 m0, s18, 57344
    s_add_u32 s8, s25, 27648
    buffer_load_dwordx4 v2, s[52:55], s25 offen lds
    buffer_load_dwordx4 v2, s[52:55], s8 offen offset:1024 lds
    s_add_u32 s25, s25, 57344
    s_cmp_eq_u32 s25, s27
    s_cselect_b32 s25, s26, s25
    v_mfma_f32_32x32x16_bf16 v[64:79], v[220:223], v[108:111], v[64:79]
    s_waitcnt lgkmcnt(0)
    v_mfma_f32_32x32x16_bf16 v[16:31], v[208:211], v[80:83], v[16:31]
    buffer_load_dwordx4 v[104:107], v11, s[60:63], s28 offen sc1
    buffer_load_dwordx4 v[108:111], v12, s[60:63], s28 offen sc1
    s_add_u32 s28, s28, 2048
    s_cmp_eq_u32 s28, s30
    s_cselect_b32 s28, s29, s28
    v_mfma_f32_32x32x16_bf16 v[32:47], v[208:211], v[84:87], v[32:47]
    s_waitcnt vmcnt(6)
    ds_read_b64_tr_b16 v[216:217], v5 offset:55296
    ds_read_b64_tr_b16 v[218:219], v5 offset:55808
    ds_read_b64_tr_b16 v[220:221], v6 offset:55296
    ds_read_b64_tr_b16 v[222:223], v6 offset:55808
    v_mfma_f32_32x32x16_bf16 v[48:63], v[212:215], v[80:83], v[48:63]
    s_add_u32 m0, s18, 59392
    s_add_u32 s8, s25, 27648
    buffer_load_dwordx4 v2, s[52:55], s25 offen lds
    buffer_load_dwordx4 v2, s[52:55], s8 offen offset:1024 lds
    s_add_u32 s25, s25, 57344
    s_cmp_eq_u32 s25, s27
    s_cselect_b32 s25, s26, s25
    v_mfma_f32_32x32x16_bf16 v[64:79], v[212:215], v[84:87], v[64:79]
    s_waitcnt lgkmcnt(0)
    v_mfma_f32_32x32x16_bf16 v[16:31], v[216:219], v[88:91], v[16:31]
    buffer_load_dwordx4 v[80:83], v11, s[60:63], s28 offen sc1
    buffer_load_dwordx4 v[84:87], v12, s[60:63], s28 offen sc1
    s_add_u32 s28, s28, 2048
    s_cmp_eq_u32 s28, s30
    s_cselect_b32 s28, s29, s28
    v_mfma_f32_32x32x16_bf16 v[32:47], v[216:219], v[92:95], v[32:47]
    s_waitcnt vmcnt(6)
    ds_read_b64_tr_b16 v[208:209], v5 offset:57344
    ds_read_b64_tr_b16 v[210:211], v5 offset:57856
    ds_read_b64_tr_b16 v[212:213], v6 offset:57344
    ds_read_b64_tr_b16 v[214:215], v6 offset:57856
    v_mfma_f32_32x32x16_bf16 v[48:63], v[220:223], v[88:91], v[48:63]
    s_add_u32 m0, s18, 49152
    s_add_u32 s8, s25, 27648
    buffer_load_dwordx4 v2, s[52:55], s25 offen lds
    buffer_load_dwordx4 v2, s[52:55], s8 offen offset:1024 lds
    s_add_u32 s25, s25, 57344
    s_cmp_eq_u32 s25, s27
    s_cselect_b32 s25, s26, s25
    v_mfma_f32_32x32x16_bf16 v[64:79], v[220:223], v[92:95], v[64:79]
    s_waitcnt lgkmcnt(0)
    v_mfma_f32_32x32x16_bf16 v[16:31], v[208:211], v[96:99], v[16:31]
    buffer_load_dwordx4 v[88:91], v11, s[60:63], s28 offen sc1
    buffer_load_dwordx4 v[92:95], v12, s[60:63], s28 offen sc1
    s_add_u32 s28, s28, 2048
    s_cmp_eq_u32 s28, s30
    s_cselect_b32 s28, s29, s28
    v_mfma_f32_32x32x16_bf16 v[32:47], v[208:211], v[100:103], v[32:47]
    s_waitcnt vmcnt(6)
    ds_read_b64_tr_b16 v[216:217], v5 offset:59392
    ds_read_b64_tr_b16 v[218:219], v5 offset:59904
    ds_read_b64_tr_b16 v[220:221], v6 offset:59392
    ds_read_b64_tr_b16 v[222:223], v6 offset:59904
    v_mfma_f32_32x32x16_bf16 v[48:63], v[212:215], v[96:99], v[48:63]
    s_add_u32 m0, s18, 51200
    s_add_u32 s8, s25, 27648
    buffer_load_dwordx4 v2, s[52:55], s25 offen lds
    buffer_load_dwordx4 v2, s[52:55], s8 offen offset:1024 lds
    s_add_u32 s25, s25, 57344
    s_cmp_eq_u32 s25, s27
    s_cselect_b32 s25, s26, s25
    v_mfma_f32_32x32x16_bf16 v[64:79], v[212:215], v[100:103], v[64:79]
    s_waitcnt lgkmcnt(0)
    v_mfma_f32_32x32x16_bf16 v[16:31], v[216:219], v[104:107], v[16:31]
    buffer_load_dwordx4 v[96:99], v11, s[60:63], s28 offen sc1
    buffer_load_dwordx4 v[100:103], v12, s[60:63], s28 offen sc1
    s_add_u32 s28, s28, 2048
    s_cmp_eq_u32 s28, s30
    s_cselect_b32 s28, s29, s28
    v_mfma_f32_32x32x16_bf16 v[32:47], v[216:219], v[108:111], v[32:47]
    s_waitcnt vmcnt(6)
    ds_read_b64_tr_b16 v[208:209], v5 offset:49152
    ds_read_b64_tr_b16 v[210:211], v5 offset:49664
    ds_read_b64_tr_b16 v[212:213], v6 offset:49152
    ds_read_b64_tr_b16 v[214:215], v6 offset:49664
    v_mfma_f32_32x32x16_bf16 v[48:63], v[220:223], v[104:107], v[48:63]
    s_add_u32 m0, s18, 53248
    s_add_u32 s8, s25, 27648
    buffer_load_dwordx4 v2, s[52:55], s25 offen lds
    buffer_load_dwordx4 v2, s[52:55], s8 offen offset:1024 lds
    s_add_u32 s25, s25, 57344
    s_cmp_eq_u32 s25, s27
    s_cselect_b32 s25, s26, s25
    v_mfma_f32_32x32x16_bf16 v[64:79], v[220:223], v[108:111], v[64:79]
    s_waitcnt lgkmcnt(0)
    v_mfma_f32_32x32x16_bf16 v[16:31], v[208:211], v[80:83], v[16:31]
    buffer_load_dwordx4 v[104:107], v11, s[60:63], s28 offen sc1
    buffer_load_dwordx4 v[108:111], v12, s[60:63], s28 offen sc1
    s_add_u32 s28, s28, 2048
    s_cmp_eq_u32 s28, s30
    s_cselect_b32 s28, s29, s28
    v_mfma_f32_32x32x16_bf16 v[32:47], v[208:211], v[84:87], v[32:47]
    s_waitcnt vmcnt(6)
    ds_read_b64_tr_b16 v[216:217], v5 offset:51200
    ds_read_b64_tr_b16 v[218:219], v5 offset:51712
    ds_read_b64_tr_b16 v[220:221], v6 offset:51200
    ds_read_b64_tr_b16 v[222:223], v6 offset:51712
    v_mfma_f32_32x32x16_bf16 v[48:63], v[212:215], v[80:83], v[48:63]
    s_add_u32 m0, s18, 55296
    s_add_u32 s8, s25, 27648
    buffer_load_dwordx4 v2, s[52:55], s25 offen lds
    buffer_load_dwordx4 v2, s[52:55], s8 offen offset:1024 lds
    s_add_u32 s25, s25, 57344
    s_cmp_eq_u32 s25, s27
    s_cselect_b32 s25, s26, s25
    v_mfma_f32_32x32x16_bf16 v[64:79], v[212:215], v[84:87], v[64:79]
    s_waitcnt lgkmcnt(0)
    v_mfma_f32_32x32x16_bf16 v[16:31], v[216:219], v[88:91], v[16:31]
    buffer_load_dwordx4 v[80:83], v11, s[60:63], s28 offen sc1
    buffer_load_dwordx4 v[84:87], v12, s[60:63], s28 offen sc1
    s_add_u32 s28, s28, 2048
    s_cmp_eq_u32 s28, s30
    s_cselect_b32 s28, s29, s28
    v_mfma_f32_32x32x16_bf16 v[32:47], v[216:219], v[92:95], v[32:47]
    s_waitcnt vmcnt(6)
    ds_read_b64_tr_b16 v[208:209], v5 offset:53248
    ds_read_b64_tr_b16 v[210:211], v5 offset:53760
    ds_read_b64_tr_b16 v[212:213], v6 offset:53248
    ds_read_b64_tr_b16 v[214:215], v6 offset:53760
    v_mfma_f32_32x32x16_bf16 v[48:63], v[220:223], v[88:91], v[48:63]
    s_add_u32 m0, s18, 57344
    s_add_u32 s8, s25, 27648
    buffer_load_dwordx4 v2, s[52:55], s25 offen lds
    buffer_load_dwordx4 v2, s[52:55], s8 offen offset:1024 lds
    s_add_u32 s25, s25, 57344
    s_cmp_eq_u32 s25, s27
    s_cselect_b32 s25, s26, s25
    v_mfma_f32_32x32x16_bf16 v[64:79], v[220:223], v[92:95], v[64:79]
    s_waitcnt lgkmcnt(0)
    v_mfma_f32_32x32x16_bf16 v[16:31], v[208:211], v[96:99], v[16:31]
    buffer_load_dwordx4 v[88:91], v11, s[60:63], s28 offen sc1
    buffer_load_dwordx4 v[92:95], v12, s[60:63], s28 offen sc1
    s_add_u32 s28, s28, 2048
    s_cmp_eq_u32 s28, s30
    s_cselect_b32 s28, s29, s28
    v_mfma_f32_32x32x16_bf16 v[32:47], v[208:211], v[100:103], v[32:47]
    s_waitcnt vmcnt(6)
    ds_read_b64_tr_b16 v[216:217], v5 offset:55296
    ds_read_b64_tr_b16 v[218:219], v5 offset:55808
    ds_read_b64_tr_b16 v[220:221], v6 offset:55296
    ds_read_b64_tr_b16 v[222:223], v6 offset:55808
    v_mfma_f32_32x32x16_bf16 v[48:63], v[212:215], v[96:99], v[48:63]
    s_add_u32 m0, s18, 59392
    s_add_u32 s8, s25, 27648
    buffer_load_dwordx4 v2, s[52:55], s25 offen lds
    buffer_load_dwordx4 v2, s[52:55], s8 offen offset:1024 lds
    s_add_u32 s25, s25, 57344
    s_cmp_eq_u32 s25, s27
    s_cselect_b32 s25, s26, s25
    v_mfma_f32_32x32x16_bf16 v[64:79], v[212:215], v[100:103], v[64:79]
    s_waitcnt lgkmcnt(0)
    v_mfma_f32_32x32x16_bf16 v[16:31], v[216:219], v[104:107], v[16:31]
    buffer_load_dwordx4 v[96:99], v11, s[60:63], s28 offen sc1
    buffer_load_dwordx4 v[100:103], v12, s[60:63], s28 offen sc1
    s_add_u32 s28, s28, 2048
    s_cmp_eq_u32 s28, s30
    s_cselect_b32 s28, s29, s28
    v_mfma_f32_32x32x16_bf16 v[32:47], v[216:219], v[108:111], v[32:47]
    s_waitcnt vmcnt(6)
    ds_read_b64_tr_b16 v[208:209], v5 offset:57344
    ds_read_b64_tr_b16 v[210:211], v5 offset:57856
    ds_read_b64_tr_b16 v[212:213], v6 offset:57344
    ds_read_b64_tr_b16 v[214:215], v6 offset:57856
    v_mfma_f32_32x32x16_bf16 v[48:63], v[220:223], v[104:107], v[48:63]
    s_add_u32 m0, s18, 49152
    s_add_u32 s8, s25, 27648
    buffer_load_dwordx4 v2, s[52:55], s25 offen lds
    buffer_load_dwordx4 v2, s[52:55], s8 offen offset:1024 lds
    s_add_u32 s25, s25, 57344
    s_cmp_eq_u32 s25, s27
    s_cselect_b32 s25, s26, s25
    v_mfma_f32_32x32x16_bf16 v[64:79], v[220:223], v[108:111], v[64:79]
    s_waitcnt lgkmcnt(0)
    v_mfma_f32_32x32x16_bf16 v[16:31], v[208:211], v[80:83], v[16:31]
    buffer_load_dwordx4 v[104:107], v11, s[60:63], s28 offen sc1
    buffer_load_dwordx4 v[108:111], v12, s[60:63], s28 offen sc1
    s_add_u32 s28, s28, 2048
    s_cmp_eq_u32 s28, s30
    s_cselect_b32 s28, s29, s28
    v_mfma_f32_32x32x16_bf16 v[32:47], v[208:211], v[84:87], v[32:47]
    s_waitcnt vmcnt(6)
    ds_read_b64_tr_b16 v[216:217], v5 offset:59392
    ds_read_b64_tr_b16 v[218:219], v5 offset:59904
    ds_read_b64_tr_b16 v[220:221], v6 offset:59392
    ds_read_b64_tr_b16 v[222:223], v6 offset:59904
    v_mfma_f32_32x32x16_bf16 v[48:63], v[212:215], v[80:83], v[48:63]
    s_add_u32 m0, s18, 51200
    s_add_u32 s8, s25, 27648
    buffer_load_dwordx4 v2, s[52:55], s25 offen lds
    buffer_load_dwordx4 v2, s[52:55], s8 offen offset:1024 lds
    s_add_u32 s25, s25, 57344
    s_cmp_eq_u32 s25, s27
    s_cselect_b32 s25, s26, s25
    v_mfma_f32_32x32x16_bf16 v[64:79], v[212:215], v[84:87], v[64:79]
    s_waitcnt lgkmcnt(0)
    v_mfma_f32_32x32x16_bf16 v[16:31], v[216:219], v[88:91], v[16:31]
    buffer_load_dwordx4 v[80:83], v11, s[60:63], s28 offen sc1
    buffer_load_dwordx4 v[84:87], v12, s[60:63], s28 offen sc1
    s_add_u32 s28, s28, 2048
    s_cmp_eq_u32 s28, s30
    s_cselect_b32 s28, s29, s28
    v_mfma_f32_32x32x16_bf16 v[32:47], v[216:219], v[92:95], v[32:47]
    s_waitcnt vmcnt(6)
    ds_read_b64_tr_b16 v[208:209], v5 offset:49152
    ds_read_b64_tr_b16 v[210:211], v5 offset:49664
    ds_read_b64_tr_b16 v[212:213], v6 offset:49152
    ds_read_b64_tr_b16 v[214:215], v6 offset:49664
    v_mfma_f32_32x32x16_bf16 v[48:63], v[220:223], v[88:91], v[48:63]
    s_add_u32 m0, s18, 53248
    s_add_u32 s8, s25, 27648
    buffer_load_dwordx4 v2, s[52:55], s25 offen lds
    buffer_load_dwordx4 v2, s[52:55], s8 offen offset:1024 lds
    s_add_u32 s25, s25, 57344
    s_cmp_eq_u32 s25, s27
    s_cselect_b32 s25, s26, s25
    v_mfma_f32_32x32x16_bf16 v[64:79], v[220:223], v[92:95], v[64:79]
    s_waitcnt lgkmcnt(0)
    v_mfma_f32_32x32x16_bf16 v[16:31], v[208:211], v[96:99], v[16:31]
    buffer_load_dwordx4 v[88:91], v11, s[60:63], s28 offen sc1
    buffer_load_dwordx4 v[92:95], v12, s[60:63], s28 offen sc1
    s_add_u32 s28, s28, 2048
    s_cmp_eq_u32 s28, s30
    s_cselect_b32 s28, s29, s28
    v_mfma_f32_32x32x16_bf16 v[32:47], v[208:211], v[100:103], v[32:47]
    s_waitcnt vmcnt(6)
    ds_read_b64_tr_b16 v[216:217], v5 offset:51200
    ds_read_b64_tr_b16 v[218:219], v5 offset:51712
    ds_read_b64_tr_b16 v[220:221], v6 offset:51200
    ds_read_b64_tr_b16 v[222:223], v6 offset:51712
    v_mfma_f32_32x32x16_bf16 v[48:63], v[212:215], v[96:99], v[48:63]
    s_add_u32 m0, s18, 55296
    s_add_u32 s8, s25, 27648
    buffer_load_dwordx4 v2, s[52:55], s25 offen lds
    buffer_load_dwordx4 v2, s[52:55], s8 offen offset:1024 lds
    s_add_u32 s25, s25, 57344
    s_cmp_eq_u32 s25, s27
    s_cselect_b32 s25, s26, s25
    v_mfma_f32_32x32x16_bf16 v[64:79], v[212:215], v[100:103], v[64:79]
    s_waitcnt lgkmcnt(0)
    v_mfma_f32_32x32x16_bf16 v[16:31], v[216:219], v[104:107], v[16:31]
    buffer_load_dwordx4 v[96:99], v11, s[60:63], s28 offen sc1
    buffer_load_dwordx4 v[100:103], v12, s[60:63], s28 offen sc1
    s_add_u32 s28, s28, 2048
    s_cmp_eq_u32 s28, s30
    s_cselect_b32 s28, s29, s28
    v_mfma_f32_32x32x16_bf16 v[32:47], v[216:219], v[108:111], v[32:47]
    s_waitcnt vmcnt(6)
    ds_read_b64_tr_b16 v[208:209], v5 offset:53248
    ds_read_b64_tr_b16 v[210:211], v5 offset:53760
    ds_read_b64_tr_b16 v[212:213], v6 offset:53248
    ds_read_b64_tr_b16 v[214:215], v6 offset:53760
    v_mfma_f32_32x32x16_bf16 v[48:63], v[220:223], v[104:107], v[48:63]
    s_add_u32 m0, s18, 57344
    s_add_u32 s8, s25, 27648
    buffer_load_dwordx4 v2, s[52:55], s25 offen lds
    buffer_load_dwordx4 v2, s[52:55], s8 offen offset:1024 lds
    s_add_u32 s25, s25, 57344
    s_cmp_eq_u32 s25, s27
    s_cselect_b32 s25, s26, s25
    v_mfma_f32_32x32x16_bf16 v[64:79], v[220:223], v[108:111], v[64:79]
    s_waitcnt lgkmcnt(0)
    v_mfma_f32_32x32x16_bf16 v[16:31], v[208:211], v[80:83], v[16:31]
    buffer_load_dwordx4 v[104:107], v11, s[60:63], s28 offen sc1
    buffer_load_dwordx4 v[108:111], v12, s[60:63], s28 offen sc1
    s_add_u32 s28, s28, 2048
    s_cmp_eq_u32 s28, s30
    s_cselect_b32 s28, s29, s28
    v_mfma_f32_32x32x16_bf16 v[32:47], v[208:211], v[84:87], v[32:47]
    s_waitcnt vmcnt(6)
    ds_read_b64_tr_b16 v[216:217], v5 offset:55296
    ds_read_b64_tr_b16 v[218:219], v5 offset:55808
    ds_read_b64_tr_b16 v[220:221], v6 offset:55296
    ds_read_b64_tr_b16 v[222:223], v6 offset:55808
    v_mfma_f32_32x32x16_bf16 v[48:63], v[212:215], v[80:83], v[48:63]
    s_add_u32 m0, s18, 59392
    s_add_u32 s8, s25, 27648
    buffer_load_dwordx4 v2, s[52:55], s25 offen lds
    buffer_load_dwordx4 v2, s[52:55], s8 offen offset:1024 lds
    s_add_u32 s25, s25, 57344
    s_cmp_eq_u32 s25, s27
    s_cselect_b32 s25, s26, s25
    v_mfma_f32_32x32x16_bf16 v[64:79], v[212:215], v[84:87], v[64:79]
    s_waitcnt lgkmcnt(0)
    v_mfma_f32_32x32x16_bf16 v[16:31], v[216:219], v[88:91], v[16:31]
    buffer_load_dwordx4 v[80:83], v11, s[60:63], s28 offen sc1
    buffer_load_dwordx4 v[84:87], v12, s[60:63], s28 offen sc1
    s_add_u32 s28, s28, 2048
    s_cmp_eq_u32 s28, s30
    s_cselect_b32 s28, s29, s28
    v_mfma_f32_32x32x16_bf16 v[32:47], v[216:219], v[92:95], v[32:47]
    s_waitcnt vmcnt(6)
    ds_read_b64_tr_b16 v[208:209], v5 offset:57344
    ds_read_b64_tr_b16 v[210:211], v5 offset:57856
    ds_read_b64_tr_b16 v[212:213], v6 offset:57344
    ds_read_b64_tr_b16 v[214:215], v6 offset:57856
    v_mfma_f32_32x32x16_bf16 v[48:63], v[220:223], v[88:91], v[48:63]
    s_add_u32 m0, s18, 49152
    s_add_u32 s8, s25, 27648
    buffer_load_dwordx4 v2, s[52:55], s25 offen lds
    buffer_load_dwordx4 v2, s[52:55], s8 offen offset:1024 lds
    s_add_u32 s25, s25, 57344
    s_cmp_eq_u32 s25, s27
    s_cselect_b32 s25, s26, s25
    v_mfma_f32_32x32x16_bf16 v[64:79], v[220:223], v[92:95], v[64:79]
    s_waitcnt lgkmcnt(0)
    v_mfma_f32_32x32x16_bf16 v[16:31], v[208:211], v[96:99], v[16:31]
    buffer_load_dwordx4 v[88:91], v11, s[60:63], s28 offen sc1
    buffer_load_dwordx4 v[92:95], v12, s[60:63], s28 offen sc1
    s_add_u32 s28, s28, 2048
    s_cmp_eq_u32 s28, s30
    s_cselect_b32 s28, s29, s28
    v_mfma_f32_32x32x16_bf16 v[32:47], v[208:211], v[100:103], v[32:47]
    s_waitcnt vmcnt(6)
    ds_read_b64_tr_b16 v[216:217], v5 offset:59392
    ds_read_b64_tr_b16 v[218:219], v5 offset:59904
    ds_read_b64_tr_b16 v[220:221], v6 offset:59392
    ds_read_b64_tr_b16 v[222:223], v6 offset:59904
    v_mfma_f32_32x32x16_bf16 v[48:63], v[212:215], v[96:99], v[48:63]
    s_add_u32 m0, s18, 51200
    s_add_u32 s8, s25, 27648
    buffer_load_dwordx4 v2, s[52:55], s25 offen lds
    buffer_load_dwordx4 v2, s[52:55], s8 offen offset:1024 lds
    s_add_u32 s25, s25, 57344
    s_cmp_eq_u32 s25, s27
    s_cselect_b32 s25, s26, s25
    v_mfma_f32_32x32x16_bf16 v[64:79], v[212:215], v[100:103], v[64:79]
    s_waitcnt lgkmcnt(0)
    v_mfma_f32_32x32x16_bf16 v[16:31], v[216:219], v[104:107], v[16:31]
    buffer_load_dwordx4 v[96:99], v11, s[60:63], s28 offen sc1
    buffer_load_dwordx4 v[100:103], v12, s[60:63], s28 offen sc1
    s_add_u32 s28, s28, 2048
    s_cmp_eq_u32 s28, s30
    s_cselect_b32 s28, s29, s28
    v_mfma_f32_32x32x16_bf16 v[32:47], v[216:219], v[108:111], v[32:47]
    s_waitcnt vmcnt(6)
    ds_read_b64_tr_b16 v[208:209], v5 offset:49152
    ds_read_b64_tr_b16 v[210:211], v5 offset:49664
    ds_read_b64_tr_b16 v[212:213], v6 offset:49152
    ds_read_b64_tr_b16 v[214:215], v6 offset:49664
    v_mfma_f32_32x32x16_bf16 v[48:63], v[220:223], v[104:107], v[48:63]
    s_add_u32 m0, s18, 53248
    s_add_u32 s8, s25, 27648
    buffer_load_dwordx4 v2, s[52:55], s25 offen lds
    buffer_load_dwordx4 v2, s[52:55], s8 offen offset:1024 lds
    s_add_u32 s25, s25, 57344
    s_cmp_eq_u32 s25, s27
    s_cselect_b32 s25, s26, s25
    v_mfma_f32_32x32x16_bf16 v[64:79], v[220:223], v[108:111], v[64:79]
    s_waitcnt lgkmcnt(0)
    v_mfma_f32_32x32x16_bf16 v[16:31], v[208:211], v[80:83], v[16:31]
    buffer_load_dwordx4 v[104:107], v11, s[60:63], s28 offen sc1
    buffer_load_dwordx4 v[108:111], v12, s[60:63], s28 offen sc1
    s_add_u32 s28, s28, 2048
    s_cmp_eq_u32 s28, s30
    s_cselect_b32 s28, s29, s28
    v_mfma_f32_32x32x16_bf16 v[32:47], v[208:211], v[84:87], v[32:47]
    s_waitcnt vmcnt(6)
    ds_read_b64_tr_b16 v[216:217], v5 offset:51200
    ds_read_b64_tr_b16 v[218:219], v5 offset:51712
    ds_read_b64_tr_b16 v[220:221], v6 offset:51200
    ds_read_b64_tr_b16 v[222:223], v6 offset:51712
    v_mfma_f32_32x32x16_bf16 v[48:63], v[212:215], v[80:83], v[48:63]
    s_add_u32 m0, s18, 55296
    s_add_u32 s8, s25, 27648
    buffer_load_dwordx4 v2, s[52:55], s25 offen lds
    buffer_load_dwordx4 v2, s[52:55], s8 offen offset:1024 lds
    s_add_u32 s25, s25, 57344
    s_cmp_eq_u32 s25, s27
    s_cselect_b32 s25, s26, s25
    v_mfma_f32_32x32x16_bf16 v[64:79], v[212:215], v[84:87], v[64:79]
    s_waitcnt lgkmcnt(0)
    v_mfma_f32_32x32x16_bf16 v[16:31], v[216:219], v[88:91], v[16:31]
    buffer_load_dwordx4 v[80:83], v11, s[60:63], s28 offen sc1
    buffer_load_dwordx4 v[84:87], v12, s[60:63], s28 offen sc1
    s_add_u32 s28, s28, 2048
    s_cmp_eq_u32 s28, s30
    s_cselect_b32 s28, s29, s28
    v_mfma_f32_32x32x16_bf16 v[32:47], v[216:219], v[92:95], v[32:47]
    s_waitcnt vmcnt(6)
    ds_read_b64_tr_b16 v[208:209], v5 offset:53248
    ds_read_b64_tr_b16 v[210:211], v5 offset:53760
    ds_read_b64_tr_b16 v[212:213], v6 offset:53248
    ds_read_b64_tr_b16 v[214:215], v6 offset:53760
    v_mfma_f32_32x32x16_bf16 v[48:63], v[220:223], v[88:91], v[48:63]
    s_add_u32 m0, s18, 57344
    s_add_u32 s8, s25, 27648
    buffer_load_dwordx4 v2, s[52:55], s25 offen lds
    buffer_load_dwordx4 v2, s[52:55], s8 offen offset:1024 lds
    s_add_u32 s25, s25, 57344
    s_cmp_eq_u32 s25, s27
    s_cselect_b32 s25, s26, s25
    v_mfma_f32_32x32x16_bf16 v[64:79], v[220:223], v[92:95], v[64:79]
    s_waitcnt lgkmcnt(0)
    v_mfma_f32_32x32x16_bf16 v[16:31], v[208:211], v[96:99], v[16:31]
    buffer_load_dwordx4 v[88:91], v11, s[60:63], s28 offen sc1
    buffer_load_dwordx4 v[92:95], v12, s[60:63], s28 offen sc1
    s_add_u32 s28, s28, 2048
    s_cmp_eq_u32 s28, s30
    s_cselect_b32 s28, s29, s28
    v_mfma_f32_32x32x16_bf16 v[32:47], v[208:211], v[100:103], v[32:47]
    s_waitcnt vmcnt(6)
    ds_read_b64_tr_b16 v[216:217], v5 offset:55296
    ds_read_b64_tr_b16 v[218:219], v5 offset:55808
    ds_read_b64_tr_b16 v[220:221], v6 offset:55296
    ds_read_b64_tr_b16 v[222:223], v6 offset:55808
    v_mfma_f32_32x32x16_bf16 v[48:63], v[212:215], v[96:99], v[48:63]
    s_add_u32 m0, s18, 59392
    s_add_u32 s8, s25, 27648
    buffer_load_dwordx4 v2, s[52:55], s25 offen lds
    buffer_load_dwordx4 v2, s[52:55], s8 offen offset:1024 lds
    s_add_u32 s25, s25, 57344
    s_cmp_eq_u32 s25, s27
    s_cselect_b32 s25, s26, s25
    v_mfma_f32_32x32x16_bf16 v[64:79], v[212:215], v[100:103], v[64:79]
    s_waitcnt lgkmcnt(0)
    v_mfma_f32_32x32x16_bf16 v[16:31], v[216:219], v[104:107], v[16:31]
    buffer_load_dwordx4 v[96:99], v11, s[60:63], s28 offen sc1
    buffer_load_dwordx4 v[100:103], v12, s[60:63], s28 offen sc1
    s_add_u32 s28, s28, 2048
    s_cmp_eq_u32 s28, s30
    s_cselect_b32 s28, s29, s28
    v_mfma_f32_32x32x16_bf16 v[32:47], v[216:219], v[108:111], v[32:47]
    s_waitcnt vmcnt(6)
    ds_read_b64_tr_b16 v[208:209], v5 offset:57344
    ds_read_b64_tr_b16 v[210:211], v5 offset:57856
    ds_read_b64_tr_b16 v[212:213], v6 offset:57344
    ds_read_b64_tr_b16 v[214:215], v6 offset:57856
    v_mfma_f32_32x32x16_bf16 v[48:63], v[220:223], v[104:107], v[48:63]
    s_add_u32 m0, s18, 49152
    s_add_u32 s8, s25, 27648
    buffer_load_dwordx4 v2, s[52:55], s25 offen lds
    buffer_load_dwordx4 v2, s[52:55], s8 offen offset:1024 lds
    s_add_u32 s25, s25, 57344
    s_cmp_eq_u32 s25, s27
    s_cselect_b32 s25, s26, s25
    v_mfma_f32_32x32x16_bf16 v[64:79], v[220:223], v[108:111], v[64:79]
    s_waitcnt lgkmcnt(0)
    v_mfma_f32_32x32x16_bf16 v[16:31], v[208:211], v[80:83], v[16:31]
    buffer_load_dwordx4 v[104:107], v11, s[60:63], s28 offen sc1
    buffer_load_dwordx4 v[108:111], v12, s[60:63], s28 offen sc1
    s_add_u32 s28, s28, 2048
    s_cmp_eq_u32 s28, s30
    s_cselect_b32 s28, s29, s28
    v_mfma_f32_32x32x16_bf16 v[32:47], v[208:211], v[84:87], v[32:47]
    s_waitcnt vmcnt(6)
    ds_read_b64_tr_b16 v[216:217], v5 offset:59392
    ds_read_b64_tr_b16 v[218:219], v5 offset:59904
    ds_read_b64_tr_b16 v[220:221], v6 offset:59392
    ds_read_b64_tr_b16 v[222:223], v6 offset:59904
    v_mfma_f32_32x32x16_bf16 v[48:63], v[212:215], v[80:83], v[48:63]
    s_add_u32 m0, s18, 51200
    s_add_u32 s8, s25, 27648
    buffer_load_dwordx4 v2, s[52:55], s25 offen lds
    buffer_load_dwordx4 v2, s[52:55], s8 offen offset:1024 lds
    s_add_u32 s25, s25, 57344
    s_cmp_eq_u32 s25, s27
    s_cselect_b32 s25, s26, s25
    v_mfma_f32_32x32x16_bf16 v[64:79], v[212:215], v[84:87], v[64:79]
    s_waitcnt lgkmcnt(0)
    v_mfma_f32_32x32x16_bf16 v[16:31], v[216:219], v[88:91], v[16:31]
    v_mfma_f32_32x32x16_bf16 v[32:47], v[216:219], v[92:95], v[32:47]
    s_waitcnt vmcnt(4)
    ds_read_b64_tr_b16 v[208:209], v5 offset:49152
    ds_read_b64_tr_b16 v[210:211], v5 offset:49664
    ds_read_b64_tr_b16 v[212:213], v6 offset:49152
    ds_read_b64_tr_b16 v[214:215], v6 offset:49664
    v_mfma_f32_32x32x16_bf16 v[48:63], v[220:223], v[88:91], v[48:63]
    v_mfma_f32_32x32x16_bf16 v[64:79], v[220:223], v[92:95], v[64:79]
    s_waitcnt lgkmcnt(0)
    v_mfma_f32_32x32x16_bf16 v[16:31], v[208:211], v[96:99], v[16:31]
    v_mfma_f32_32x32x16_bf16 v[32:47], v[208:211], v[100:103], v[32:47]
    s_waitcnt vmcnt(0)
    ds_read_b64_tr_b16 v[216:217], v5 offset:51200
    ds_read_b64_tr_b16 v[218:219], v5 offset:51712
    ds_read_b64_tr_b16 v[220:221], v6 offset:51200
    ds_read_b64_tr_b16 v[222:223], v6 offset:51712
    v_mfma_f32_32x32x16_bf16 v[48:63], v[212:215], v[96:99], v[48:63]
    v_mfma_f32_32x32x16_bf16 v[64:79], v[212:215], v[100:103], v[64:79]
    s_waitcnt lgkmcnt(0)
    v_mfma_f32_32x32x16_bf16 v[16:31], v[216:219], v[104:107], v[16:31]
    v_mfma_f32_32x32x16_bf16 v[32:47], v[216:219], v[108:111], v[32:47]
    v_mfma_f32_32x32x16_bf16 v[48:63], v[220:223], v[104:107], v[48:63]
    v_mfma_f32_32x32x16_bf16 v[64:79], v[220:223], v[108:111], v[64:79]
    s_setprio 3
    s_add_u32 s88, s88, 12582912
    s_add_u32 s89, s89, 12582912
    buffer_store_dwordx4 v[112:115], v170, s[60:63], s88 offen sc1
    buffer_store_dwordx4 v[116:119], v170, s[60:63], s89 offen sc1
    buffer_store_dwordx4 v[120:123], v172, s[60:63], s88 offen offset:1024 sc1
    buffer_store_dwordx4 v[124:127], v172, s[60:63], s88 offen offset:1536 sc1
    s_add_u32 m0, s18, 49152
    s_add_u32 s8, s31, 7168
    buffer_load_dwordx4 v4, s[48:51], s31 offen lds
    buffer_load_dwordx4 v4, s[48:51], s8 offen offset:1024 lds
    s_add_u32 s31, s31, 16384
    s_add_u32 m0, s18, 51200
    s_add_u32 s8, s31, 7168
    buffer_load_dwordx4 v4, s[48:51], s31 offen lds
    buffer_load_dwordx4 v4, s[48:51], s8 offen offset:1024 lds
    s_add_u32 s31, s31, 16384
    s_add_u32 m0, s18, 53248
    s_add_u32 s8, s31, 7168
    buffer_load_dwordx4 v4, s[48:51], s31 offen lds
    buffer_load_dwordx4 v4, s[48:51], s8 offen offset:1024 lds
    s_add_u32 s31, s31, 16384
    v_mov_b32 v244, 156456
    s_mov_b32 s17, 1600000
L_sy_45:
    ds_read_b32 v245, v244
    s_waitcnt lgkmcnt(0)
    v_readfirstlane_b32 s8, v245
    s_cmp_ge_u32 s8, 4
    s_cbranch_scc1 L_syd_46
    s_sleep 1
    s_sub_u32 s17, s17, 1
    s_cmp_lg_u32 s17, 0
    s_cbranch_scc1 L_sy_45
    s_endpgm
L_syd_46:
    ds_write_b128 v241, v[32:35] offset:0
    ds_write_b128 v241, v[36:39] offset:1024
    ds_write_b128 v241, v[40:43] offset:2048
    ds_write_b128 v241, v[44:47] offset:3072
    ds_write_b128 v242, v[48:51] offset:0
    ds_write_b128 v242, v[52:55] offset:1024
    ds_write_b128 v242, v[56:59] offset:2048
    ds_write_b128 v242, v[60:63] offset:3072
    ds_write_b128 v243, v[64:67] offset:0
    ds_write_b128 v243, v[68:71] offset:1024
    ds_write_b128 v243, v[72:75] offset:2048
    ds_write_b128 v243, v[76:79] offset:3072
    s_waitcnt lgkmcnt(0)
    v_mov_b32 v244, 156432
    s_mov_b64 exec, 1
    ds_add_u32 v244, v1
    s_mov_b64 exec, -1
    v_mov_b32 v244, 156432
    s_mov_b32 s17, 1600000
L_sy_47:
    ds_read_b32 v245, v244
    s_waitcnt lgkmcnt(0)
    v_readfirstlane_b32 s8, v245
    s_cmp_ge_u32 s8, 4
    s_cbranch_scc1 L_syd_48
    s_sub_u32 s17, s17, 1
    s_cmp_lg_u32 s17, 0
    s_cbranch_scc1 L_sy_47
    s_endpgm
L_syd_48:
    ds_read_b128 v[32:35], v240 offset:0
    ds_read_b128 v[36:39], v240 offset:1024
    ds_read_b128 v[40:43], v240 offset:2048
    ds_read_b128 v[44:47], v240 offset:3072
    ds_read_b128 v[48:51], v240 offset:4096
    ds_read_b128 v[52:55], v240 offset:5120
    ds_read_b128 v[56:59], v240 offset:6144
    ds_read_b128 v[60:63], v240 offset:7168
    ds_read_b128 v[64:67], v240 offset:8192
    ds_read_b128 v[68:71], v240 offset:9216
    ds_read_b128 v[72:75], v240 offset:10240
    ds_read_b128 v[76:79], v240 offset:11264
    s_waitcnt lgkmcnt(8)
    v_pk_add_f32 v[16:17], v[16:17], v[32:33]
    v_pk_add_f32 v[18:19], v[18:19], v[34:35]
    v_pk_add_f32 v[20:21], v[20:21], v[36:37]
    v_pk_add_f32 v[22:23], v[22:23], v[38:39]
    v_pk_add_f32 v[24:25], v[24:25], v[40:41]
    v_pk_add_f32 v[26:27], v[26:27], v[42:43]
    v_pk_add_f32 v[28:29], v[28:29], v[44:45]
    v_pk_add_f32 v[30:31], v[30:31], v[46:47]
    s_waitcnt lgkmcnt(4)
    v_pk_add_f32 v[16:17], v[16:17], v[48:49]
    v_pk_add_f32 v[18:19], v[18:19], v[50:51]
    v_pk_add_f32 v[20:21], v[20:21], v[52:53]
    v_pk_add_f32 v[22:23], v[22:23], v[54:55]
    v_pk_add_f32 v[24:25], v[24:25], v[56:57]
    v_pk_add_f32 v[26:27], v[26:27], v[58:59]
    v_pk_add_f32 v[28:29], v[28:29], v[60:61]
    v_pk_add_f32 v[30:31], v[30:31], v[62:63]
    s_waitcnt lgkmcnt(0)
    v_pk_add_f32 v[16:17], v[16:17], v[64:65]
    v_pk_add_f32 v[18:19], v[18:19], v[66:67]
    v_pk_add_f32 v[20:21], v[20:21], v[68:69]
    v_pk_add_f32 v[22:23], v[22:23], v[70:71]
    v_pk_add_f32 v[24:25], v[24:25], v[72:73]
    v_pk_add_f32 v[26:27], v[26:27], v[74:75]
    v_pk_add_f32 v[28:29], v[28:29], v[76:77]
    v_pk_add_f32 v[30:31], v[30:31], v[78:79]
    s_mov_b32 s8, 0xbdd2d3e8
    s_mov_b32 s9, 0xbdd2d3e8
    v_mov_b32 v244, 0xc0135761
    v_mov_b32 v245, 0xc0135761
    v_pk_mul_f32 v[32:33], v[16:17], v[16:17]
    v_pk_mul_f32 v[34:35], v[18:19], v[18:19]
    v_pk_mul_f32 v[36:37], v[20:21], v[20:21]
    v_pk_mul_f32 v[38:39], v[22:23], v[22:23]
    v_pk_mul_f32 v[40:41], v[24:25], v[24:25]
    v_pk_mul_f32 v[42:43], v[26:27], v[26:27]
    v_pk_mul_f32 v[44:45], v[28:29], v[28:29]
    v_pk_mul_f32 v[46:47], v[30:31], v[30:31]
    v_pk_fma_f32 v[32:33], v[32:33], s[8:9], v[244:245]
    v_pk_fma_f32 v[34:35], v[34:35], s[8:9], v[244:245]
    v_pk_fma_f32 v[36:37], v[36:37], s[8:9], v[244:245]
    v_pk_fma_f32 v[38:39], v[38:39], s[8:9], v[244:245]
    v_pk_fma_f32 v[40:41], v[40:41], s[8:9], v[244:245]
    v_pk_fma_f32 v[42:43], v[42:43], s[8:9], v[244:245]
    v_pk_fma_f32 v[44:45], v[44:45], s[8:9], v[244:245]
    v_pk_fma_f32 v[46:47], v[46:47], s[8:9], v[244:245]
    v_pk_mul_f32 v[32:33], v[32:33], v[16:17]
    v_pk_mul_f32 v[34:35], v[34:35], v[18:19]
    v_pk_mul_f32 v[36:37], v[36:37], v[20:21]
    v_pk_mul_f32 v[38:39], v[38:39], v[22:23]
    v_pk_mul_f32 v[40:41], v[40:41], v[24:25]
    v_pk_mul_f32 v[42:43], v[42:43], v[26:27]
    v_pk_mul_f32 v[44:45], v[44:45], v[28:29]
    v_pk_mul_f32 v[46:47], v[46:47], v[30:31]
    v_exp_f32 v32, v32
    v_exp_f32 v33, v33
    v_exp_f32 v34, v34
    v_exp_f32 v35, v35
    v_exp_f32 v36, v36
    v_exp_f32 v37, v37
    v_exp_f32 v38, v38
    v_exp_f32 v39, v39
    v_exp_f32 v40, v40
    v_exp_f32 v41, v41
    v_exp_f32 v42, v42
    v_exp_f32 v43, v43
    v_exp_f32 v44, v44
    v_exp_f32 v45, v45
    v_exp_f32 v46, v46
    v_exp_f32 v47, v47
    v_pk_add_f32 v[32:33], v[32:33], 1.0 op_sel_hi:[1,0]
    v_pk_add_f32 v[34:35], v[34:35], 1.0 op_sel_hi:[1,0]
    v_pk_add_f32 v[36:37], v[36:37], 1.0 op_sel_hi:[1,0]
    v_pk_add_f32 v[38:39], v[38:39], 1.0 op_sel_hi:[1,0]
    v_pk_add_f32 v[40:41], v[40:41], 1.0 op_sel_hi:[1,0]
    v_pk_add_f32 v[42:43], v[42:43], 1.0 op_sel_hi:[1,0]
    v_pk_add_f32 v[44:45], v[44:45], 1.0 op_sel_hi:[1,0]
    v_pk_add_f32 v[46:47], v[46:47], 1.0 op_sel_hi:[1,0]
    v_rcp_f32 v32, v32
    v_rcp_f32 v33, v33
    v_rcp_f32 v34, v34
    v_rcp_f32 v35, v35
    v_rcp_f32 v36, v36
    v_rcp_f32 v37, v37
    v_rcp_f32 v38, v38
    v_rcp_f32 v39, v39
    v_rcp_f32 v40, v40
    v_rcp_f32 v41, v41
    v_rcp_f32 v42, v42
    v_rcp_f32 v43, v43
    v_rcp_f32 v44, v44
    v_rcp_f32 v45, v45
    v_rcp_f32 v46, v46
    v_rcp_f32 v47, v47
    v_pk_mul_f32 v[32:33], v[32:33], v[16:17]
    v_pk_mul_f32 v[34:35], v[34:35], v[18:19]
    v_pk_mul_f32 v[36:37], v[36:37], v[20:21]
    v_pk_mul_f32 v[38:39], v[38:39], v[22:23]
    v_pk_mul_f32 v[40:41], v[40:41], v[24:25]
    v_pk_mul_f32 v[42:43], v[42:43], v[26:27]
    v_pk_mul_f32 v[44:45], v[44:45], v[28:29]
    v_pk_mul_f32 v[46:47], v[46:47], v[30:31]
    v_cvt_pk_bf16_f32 v16, v32, v33
    v_cvt_pk_bf16_f32 v17, v34, v35
    v_cvt_pk_bf16_f32 v18, v36, v37
    v_cvt_pk_bf16_f32 v19, v38, v39
    v_cvt_pk_bf16_f32 v20, v40, v41
    v_cvt_pk_bf16_f32 v21, v42, v43
    v_cvt_pk_bf16_f32 v22, v44, v45
    v_cvt_pk_bf16_f32 v23, v46, v47
    s_mul_i32 s8, s19, 112
    s_lshl_b32 s9, s20, 2
    s_add_u32 s8, s8, s9
    s_and_b32 s9, s81, 2
    s_add_u32 s8, s8, s9
    s_lshl_b32 s8, s8, 11
    s_add_u32 s8, s8, 8388608
    buffer_store_dwordx4 v[16:19], v11, s[60:63], s8 offen sc1
    buffer_store_dwordx4 v[20:23], v11, s[60:63], s8 offen offset:2048 sc1
    s_lshl_b32 s8, s19, 12
    s_lshl_b32 s9, s20, 7
    s_add_u32 s8, s8, s9
    s_lshl_b32 s9, s81, 3
    s_add_u32 s8, s8, s9
    s_add_u32 s8, s8, 12779520
    s_mov_b32 s23, s8
    s_waitcnt vmcnt(0)
    v_mov_b32 v246, s14
    v_mov_b32 v247, s15
    v_mov_b32 v244, 0
    s_mov_b64 exec, 1
    buffer_store_dwordx2 v[246:247], v244, s[60:63], s23 offen sc1
    s_mov_b64 exec, -1
    v_mov_b32 v246, s14
    v_mov_b32 v247, s15
    v_mov_b32 v244, 0
    s_mov_b64 exec, 1
    buffer_store_dwordx2 v[246:247], v244, s[60:63], s84 offen sc1
    s_mov_b64 exec, -1
    s_branch L_skipg1e_39
L_skipg1_38:
    v_mov_b32 v244, 156452
    s_mov_b32 s17, 24
L_sy_49:
    ds_read_b32 v245, v244
    s_waitcnt lgkmcnt(0)
    v_readfirstlane_b32 s8, v245
    s_cmp_ge_u32 s8, 4
    s_cbranch_scc1 L_syd_50
    s_sleep 1
    s_sub_u32 s17, s17, 1
    s_cmp_lg_u32 s17, 0
    s_cbranch_scc1 L_sy_49
L_syd_50:
    s_and_b32 s8, s5, 3
    s_lshl_b32 s8, s8, 1
    s_lshl_b32 s9, s81, 9
    s_add_u32 s8, s8, s9
    s_add_u32 s8, s8, 128
    s_mul_i32 s9, s8, 3584
    s_add_u32 s9, s9, s90
    s_mov_b32 s10, 48
L_help_51:
    buffer_load_dwordx4 v[248:251], v174, s[52:55], s9 offen
    s_add_u32 s9, s9, 28672
    s_waitcnt vmcnt(6)
    s_sub_u32 s10, s10, 1
    s_cmp_lg_u32 s10, 0
    s_cbranch_scc1 L_help_51
    s_add_u32 s88, s88, 12582912
    s_add_u32 s89, s89, 12582912
    buffer_store_dwordx4 v[112:115], v170, s[60:63], s88 offen sc1
    buffer_store_dwordx4 v[116:119], v170, s[60:63], s89 offen sc1
    buffer_store_dwordx4 v[120:123], v172, s[60:63], s88 offen offset:1024 sc1
    buffer_store_dwordx4 v[124:127], v172, s[60:63], s88 offen offset:1536 sc1
    s_add_u32 m0, s18, 49152
    s_add_u32 s8, s31, 7168
    buffer_load_dwordx4 v4, s[48:51], s31 offen lds
    buffer_load_dwordx4 v4, s[48:51], s8 offen offset:1024 lds
    s_add_u32 s31, s31, 16384
    s_add_u32 m0, s18, 51200
    s_add_u32 s8, s31, 7168
    buffer_load_dwordx4 v4, s[48:51], s31 offen lds
    buffer_load_dwordx4 v4, s[48:51], s8 offen offset:1024 lds
    s_add_u32 s31, s31, 16384
    s_add_u32 m0, s18, 53248
    s_add_u32 s8, s31, 7168
    buffer_load_dwordx4 v4, s[48:51], s31 offen lds
    buffer_load_dwordx4 v4, s[48:51], s8 offen offset:1024 lds
    s_add_u32 s31, s31, 16384
    s_waitcnt vmcnt(0)
    v_mov_b32 v246, s14
    v_mov_b32 v247, s15
    v_mov_b32 v244, 0
    s_mov_b64 exec, 1
    buffer_store_dwordx2 v[246:247], v244, s[60:63], s84 offen sc1
    s_mov_b64 exec, -1
L_skipg1e_39:
    s_mul_i32 s26, s81, 1835008
    s_lshl_b32 s8, s21, 7
    s_add_u32 s26, s26, s8
    s_add_u32 s27, s26, 1835008
    s_mul_i32 s25, s24, 65536
    s_add_u32 s25, s25, s26
    s_mul_i32 s29, s22, 112
    s_mul_i32 s8, s81, 28
    s_add_u32 s29, s29, s8
    s_lshl_b32 s29, s29, 11
    s_add_u32 s29, s29, 8388608
    s_add_u32 s30, s29, 57344
    s_mul_i32 s28, s24, 2048
    s_add_u32 s28, s28, s29
    ds_read_b64_tr_b16 v[144:145], v9 offset:49152
    ds_read_b64_tr_b16 v[146:147], v9 offset:50176
    ds_read_b64_tr_b16 v[148:149], v10 offset:49152
    ds_read_b64_tr_b16 v[150:151], v10 offset:50176
    s_waitcnt lgkmcnt(0)
    s_add_u32 m0, s18, 55296
    s_add_u32 s8, s31, 7168
    buffer_load_dwordx4 v4, s[48:51], s31 offen lds
    buffer_load_dwordx4 v4, s[48:51], s8 offen offset:1024 lds
    s_add_u32 s31, s31, 16384
    ds_read_b64_tr_b16 v[152:153], v9 offset:51200
    ds_read_b64_tr_b16 v[154:155], v9 offset:52224
    ds_read_b64_tr_b16 v[156:157], v10 offset:51200
    ds_read_b64_tr_b16 v[158:159], v10 offset:52224
    s_waitcnt lgkmcnt(0)
    s_add_u32 m0, s18, 57344
    s_add_u32 s8, s31, 7168
    buffer_load_dwordx4 v4, s[48:51], s31 offen lds
    buffer_load_dwordx4 v4, s[48:51], s8 offen offset:1024 lds
    s_add_u32 s31, s31, 16384
    ds_read_b64_tr_b16 v[160:161], v9 offset:53248
    ds_read_b64_tr_b16 v[162:163], v9 offset:54272
    ds_read_b64_tr_b16 v[164:165], v10 offset:53248
    ds_read_b64_tr_b16 v[166:167], v10 offset:54272
    s_waitcnt lgkmcnt(0)
    s_add_u32 m0, s18, 59392
    s_add_u32 s8, s31, 7168
    buffer_load_dwordx4 v4, s[48:51], s31 offen lds
    buffer_load_dwordx4 v4, s[48:51], s8 offen offset:1024 lds
    s_add_u32 s31, s31, 16384
    s_waitcnt vmcnt(4)
    ds_read_b64_tr_b16 v[168:169], v9 offset:55296
    ds_read_b64_tr_b16 v[170:171], v9 offset:56320
    ds_read_b64_tr_b16 v[172:173], v10 offset:55296
    ds_read_b64_tr_b16 v[174:175], v10 offset:56320
    s_waitcnt lgkmcnt(0)
    s_add_u32 m0, s18, 49152
    s_add_u32 s8, s31, 7168
    buffer_load_dwordx4 v4, s[48:51], s31 offen lds
    buffer_load_dwordx4 v4, s[48:51], s8 offen offset:1024 lds
    s_add_u32 s31, s31, 16384
    s_waitcnt vmcnt(4)
    ds_read_b64_tr_b16 v[176:177], v9 offset:57344
    ds_read_b64_tr_b16 v[178:179], v9 offset:58368
    ds_read_b64_tr_b16 v[180:181], v10 offset:57344
    ds_read_b64_tr_b16 v[182:183], v10 offset:58368
    s_waitcnt lgkmcnt(0)
    s_add_u32 m0, s18, 51200
    s_add_u32 s8, s31, 7168
    buffer_load_dwordx4 v4, s[48:51], s31 offen lds
    buffer_load_dwordx4 v4, s[48:51], s8 offen offset:1024 lds
    s_add_u32 s31, s31, 16384
    s_waitcnt vmcnt(4)
    ds_read_b64_tr_b16 v[184:185], v9 offset:59392
    ds_read_b64_tr_b16 v[186:187], v9 offset:60416
    ds_read_b64_tr_b16 v[188:189], v10 offset:59392
    ds_read_b64_tr_b16 v[190:191], v10 offset:60416
    s_waitcnt lgkmcnt(0)
    s_add_u32 m0, s18, 0
    s_add_u32 s8, s25, 31744
    buffer_load_dwordx4 v3, s[56:59], s25 offen lds
    buffer_load_dwordx4 v3, s[56:59], s8 offen offset:1024 lds
    s_add_u32 s25, s25, 65536
    s_cmp_eq_u32 s25, s27
    s_cselect_b32 s25, s26, s25
    s_waitcnt vmcnt(4)
    ds_read_b64_tr_b16 v[192:193], v9 offset:49152
    ds_read_b64_tr_b16 v[194:195], v9 offset:50176
    ds_read_b64_tr_b16 v[196:197], v10 offset:49152
    ds_read_b64_tr_b16 v[198:199], v10 offset:50176
    s_waitcnt lgkmcnt(0)
    s_add_u32 m0, s18, 2048
    s_add_u32 s8, s25, 31744
    buffer_load_dwordx4 v3, s[56:59], s25 offen lds
    buffer_load_dwordx4 v3, s[56:59], s8 offen offset:1024 lds
    s_add_u32 s25, s25, 65536
    s_cmp_eq_u32 s25, s27
    s_cselect_b32 s25, s26, s25
    s_waitcnt vmcnt(4)
    ds_read_b64_tr_b16 v[200:201], v9 offset:51200
    ds_read_b64_tr_b16 v[202:203], v9 offset:52224
    ds_read_b64_tr_b16 v[204:205], v10 offset:51200
    ds_read_b64_tr_b16 v[206:207], v10 offset:52224
    s_waitcnt lgkmcnt(0)
    s_add_u32 m0, s18, 4096
    s_add_u32 s8, s25, 31744
    buffer_load_dwordx4 v3, s[56:59], s25 offen lds
    buffer_load_dwordx4 v3, s[56:59], s8 offen offset:1024 lds
    s_add_u32 s25, s25, 65536
    s_cmp_eq_u32 s25, s27
    s_cselect_b32 s25, s26, s25
    s_waitcnt vmcnt(4)
    s_add_u32 m0, s18, 6144
    s_add_u32 s8, s25, 31744
    buffer_load_dwordx4 v3, s[56:59], s25 offen lds
    buffer_load_dwordx4 v3, s[56:59], s8 offen offset:1024 lds
    s_add_u32 s25, s25, 65536
    s_cmp_eq_u32 s25, s27
    s_cselect_b32 s25, s26, s25
    s_waitcnt vmcnt(4)
    s_add_u32 m0, s18, 8192
    s_add_u32 s8, s25, 31744
    buffer_load_dwordx4 v3, s[56:59], s25 offen lds
    buffer_load_dwordx4 v3, s[56:59], s8 offen offset:1024 lds
    s_add_u32 s25, s25, 65536
    s_cmp_eq_u32 s25, s27
    s_cselect_b32 s25, s26, s25
    s_waitcnt vmcnt(4)
    s_add_u32 m0, s18, 10240
    s_add_u32 s8, s25, 31744
    buffer_load_dwordx4 v3, s[56:59], s25 offen lds
    buffer_load_dwordx4 v3, s[56:59], s8 offen offset:1024 lds
    s_add_u32 s25, s25, 65536
    s_cmp_eq_u32 s25, s27
    s_cselect_b32 s25, s26, s25
    s_waitcnt vmcnt(4)
    s_add_u32 m0, s18, 53248
    s_add_u32 s8, s25, 31744
    buffer_load_dwordx4 v3, s[56:59], s25 offen lds
    buffer_load_dwordx4 v3, s[56:59], s8 offen offset:1024 lds
    s_add_u32 s25, s25, 65536
    s_cmp_eq_u32 s25, s27
    s_cselect_b32 s25, s26, s25
    s_waitcnt vmcnt(4)
    s_add_u32 m0, s18, 55296
    s_add_u32 s8, s25, 31744
    buffer_load_dwordx4 v3, s[56:59], s25 offen lds
    buffer_load_dwordx4 v3, s[56:59], s8 offen offset:1024 lds
    s_add_u32 s25, s25, 65536
    s_cmp_eq_u32 s25, s27
    s_cselect_b32 s25, s26, s25
    s_waitcnt vmcnt(4)
    s_add_u32 m0, s18, 57344
    s_add_u32 s8, s25, 31744
    buffer_load_dwordx4 v3, s[56:59], s25 offen lds
    buffer_load_dwordx4 v3, s[56:59], s8 offen offset:1024 lds
    s_add_u32 s25, s25, 65536
    s_cmp_eq_u32 s25, s27
    s_cselect_b32 s25, s26, s25
    s_waitcnt vmcnt(4)
    s_add_u32 m0, s18, 59392
    s_add_u32 s8, s25, 31744
    buffer_load_dwordx4 v3, s[56:59], s25 offen lds
    buffer_load_dwordx4 v3, s[56:59], s8 offen offset:1024 lds
    s_add_u32 s25, s25, 65536
    s_cmp_eq_u32 s25, s27
    s_cselect_b32 s25, s26, s25
    v_lshlrev_b32 v16, 16, v15
    v_lshlrev_b32 v17, 16, v15
    v_lshlrev_b32 v18, 16, v15
    v_lshlrev_b32 v19, 16, v15
    v_lshlrev_b32 v20, 16, v15
    v_lshlrev_b32 v21, 16, v15
    v_lshlrev_b32 v22, 16, v15
    v_lshlrev_b32 v23, 16, v15
    v_lshlrev_b32 v24, 16, v15
    v_lshlrev_b32 v25, 16, v15
    v_lshlrev_b32 v26, 16, v15
    v_lshlrev_b32 v27, 16, v15
    v_lshlrev_b32 v28, 16, v15
    v_lshlrev_b32 v29, 16, v15
    v_lshlrev_b32 v30, 16, v15
    v_lshlrev_b32 v31, 16, v15
    v_min_u32 v244, 27, v0
    v_lshrrev_b32 v245, 2, v244
    v_and_b32 v244, 3, v244
    v_lshlrev_b32 v244, 3, v244
    v_lshl_add_u32 v244, v245, 7, v244
    s_lshl_b32 s9, s22, 12
    s_mul_i32 s8, s81, 896
    s_add_u32 s9, s9, s8
    s_add_u32 s9, s9, 12779520
    s_cmp_lt_u32 s5, 28
    s_cbranch_scc1 L_nohelp_52
    v_lshrrev_b32 v224, 5, v0
    v_and_b32 v225, 31, v0
    v_lshlrev_b32 v225, 4, v225
    v_lshl_add_u32 v224, v224, 12, v225
    s_and_b32 s8, s5, 3
    s_lshl_b32 s8, s8, 2
    s_add_u32 s8, s8, s81
    s_lshl_b32 s32, s8, 13
    s_lshl_b32 s8, s4, 9
    s_add_u32 s32, s32, s8
    s_mov_b32 s33, 8
L_help2_53:
    buffer_load_dwordx2 v[246:247], v244, s[60:63], s9 offen sc1
    buffer_load_dwordx4 v[248:251], v224, s[56:59], s32 offen
    s_add_u32 s32, s32, 131072
    s_waitcnt vmcnt(6)
    buffer_load_dwordx4 v[248:251], v224, s[56:59], s32 offen
    s_add_u32 s32, s32, 131072
    s_waitcnt vmcnt(6)
    buffer_load_dwordx4 v[248:251], v224, s[56:59], s32 offen
    s_add_u32 s32, s32, 131072
    s_waitcnt vmcnt(6)
    buffer_load_dwordx4 v[248:251], v224, s[56:59], s32 offen
    s_add_u32 s32, s32, 131072
    s_waitcnt vmcnt(6)
    buffer_load_dwordx4 v[248:251], v224, s[56:59], s32 offen
    s_add_u32 s32, s32, 131072
    s_waitcnt vmcnt(6)
    buffer_load_dwordx4 v[248:251], v224, s[56:59], s32 offen
    s_add_u32 s32, s32, 131072
    s_waitcnt vmcnt(6)
    buffer_load_dwordx4 v[248:251], v224, s[56:59], s32 offen
    s_add_u32 s32, s32, 131072
    s_waitcnt vmcnt(6)
    v_cmp_ne_u64 vcc, s[14:15], v[246:247]
    s_and_b32 s10, vcc_lo, 0x0fffffff
    s_and_b32 s11, vcc_hi, 0
    s_or_b32 s10, s10, s11
    s_cmp_eq_u32 s10, 0
    s_cbranch_scc1 L_nohelp_52
    s_sub_u32 s33, s33, 1
    s_cmp_lg_u32 s33, 0
    s_cbranch_scc1 L_help2_53
L_nohelp_52:
    s_mov_b32 s17, 200000
L_poll_54:
    buffer_load_dwordx2 v[246:247], v244, s[60:63], s9 offen sc1
    s_waitcnt vmcnt(0)
    v_cmp_ne_u64 vcc, s[14:15], v[246:247]
    s_and_b32 s10, vcc_lo, 0x0fffffff
    s_and_b32 s11, vcc_hi, 0
    s_or_b32 s10, s10, s11
    s_cmp_eq_u32 s10, 0
    s_cbranch_scc1 L_pollok_55
    s_sleep 2
    s_sub_u32 s17, s17, 1
    s_cmp_lg_u32 s17, 0
    s_cbranch_scc1 L_poll_54
    s_endpgm
L_pollok_55:
    v_and_b32 v244, 31, v0
    v_lshlrev_b32 v245, 2, v244
    s_mov_b32 s23, s91
    s_lshl_b32 s9, s23, 2
    s_add_u32 s9, s9, 12582912
    buffer_load_dword v224, v245, s[60:63], s9 offen sc1
    s_xor_b32 s9, s9, 128
    buffer_load_dword v226, v245, s[60:63], s9 offen sc1
    v_and_b32 v15, 31, v0
    v_lshlrev_b32 v15, 10, v15
    v_lshrrev_b32 v244, 5, v0
    v_lshl_add_u32 v15, v244, 4, v15
    s_lshl_b32 s23, s23, 10
    s_lshl_b32 s8, s22, 7
    s_add_u32 s23, s23, s8
    s_lshr_b32 s8, s81, 1
    s_lshl_b32 s8, s8, 6
    s_add_u32 s23, s23, s8
    s_lshl_b32 s32, s21, 16
    s_lshl_b32 s8, s81, 14
    s_add_u32 s32, s32, s8
    s_add_u32 s32, s32, 10485760
    v_min_u32 v228, 7, v0
    v_lshrrev_b32 v244, 1, v228
    v_and_b32 v228, 1, v228
    v_lshlrev_b32 v228, 3, v228
    v_lshl_add_u32 v228, v244, 7, v228
    s_lshr_b32 s33, s21, 1
    s_lshl_b32 s33, s33, 11
    s_lshl_b32 s8, s81, 9
    s_add_u32 s33, s33, s8
    s_and_b32 s8, s21, 1
    s_lshl_b32 s8, s8, 4
    s_add_u32 s33, s33, s8
    s_add_u32 s33, s33, 12845056
    v_mov_b32 v247, 156416
    s_setprio 0
    buffer_load_dwordx4 v[80:83], v13, s[60:63], s28 offen sc1
    buffer_load_dwordx4 v[84:87], v14, s[60:63], s28 offen sc1
    s_add_u32 s28, s28, 2048
    s_cmp_eq_u32 s28, s30
    s_cselect_b32 s28, s29, s28
    buffer_load_dwordx4 v[88:91], v13, s[60:63], s28 offen sc1
    buffer_load_dwordx4 v[92:95], v14, s[60:63], s28 offen sc1
    s_add_u32 s28, s28, 2048
    s_cmp_eq_u32 s28, s30
    s_cselect_b32 s28, s29, s28
    buffer_load_dwordx4 v[96:99], v13, s[60:63], s28 offen sc1
    buffer_load_dwordx4 v[100:103], v14, s[60:63], s28 offen sc1
    s_add_u32 s28, s28, 2048
    s_cmp_eq_u32 s28, s30
    s_cselect_b32 s28, s29, s28
    ds_read_b64_tr_b16 v[208:209], v7 offset:0
    ds_read_b64_tr_b16 v[210:211], v7 offset:1024
    ds_read_b64_tr_b16 v[212:213], v8 offset:0
    ds_read_b64_tr_b16 v[214:215], v8 offset:1024
    s_waitcnt vmcnt(4)
    s_waitcnt lgkmcnt(0)
    v_mfma_f32_32x32x16_bf16 v[16:31], v[80:83], v[208:211], v[16:31]
    buffer_load_dwordx4 v[104:107], v13, s[60:63], s28 offen sc1
    buffer_load_dwordx4 v[108:111], v14, s[60:63], s28 offen sc1
    s_add_u32 s28, s28, 2048
    s_cmp_eq_u32 s28, s30
    s_cselect_b32 s28, s29, s28
    v_mfma_f32_32x32x16_bf16 v[48:63], v[84:87], v[208:211], 0
    ds_read_b64_tr_b16 v[216:217], v7 offset:2048
    ds_read_b64_tr_b16 v[218:219], v7 offset:3072
    ds_read_b64_tr_b16 v[220:221], v8 offset:2048
    ds_read_b64_tr_b16 v[222:223], v8 offset:3072
    v_mfma_f32_32x32x16_bf16 v[32:47], v[80:83], v[212:215], 0
    v_mfma_f32_32x32x16_bf16 v[64:79], v[84:87], v[212:215], 0
    s_waitcnt vmcnt(4)
    s_waitcnt lgkmcnt(0)
    v_mfma_f32_32x32x16_bf16 v[16:31], v[88:91], v[216:219], v[16:31]
    buffer_load_dwordx4 v[80:83], v13, s[60:63], s28 offen sc1
    buffer_load_dwordx4 v[84:87], v14, s[60:63], s28 offen sc1
    s_add_u32 s28, s28, 2048
    s_cmp_eq_u32 s28, s30
    s_cselect_b32 s28, s29, s28
    v_mfma_f32_32x32x16_bf16 v[48:63], v[92:95], v[216:219], v[48:63]
    ds_read_b64_tr_b16 v[208:209], v7 offset:4096
    ds_read_b64_tr_b16 v[210:211], v7 offset:5120
    ds_read_b64_tr_b16 v[212:213], v8 offset:4096
    ds_read_b64_tr_b16 v[214:215], v8 offset:5120
    v_mfma_f32_32x32x16_bf16 v[32:47], v[88:91], v[220:223], v[32:47]
    v_mfma_f32_32x32x16_bf16 v[64:79], v[92:95], v[220:223], v[64:79]
    s_waitcnt vmcnt(4)
    s_waitcnt lgkmcnt(0)
    v_mfma_f32_32x32x16_bf16 v[16:31], v[96:99], v[208:211], v[16:31]
    buffer_load_dwordx4 v[88:91], v13, s[60:63], s28 offen sc1
    buffer_load_dwordx4 v[92:95], v14, s[60:63], s28 offen sc1
    s_add_u32 s28, s28, 2048
    s_cmp_eq_u32 s28, s30
    s_cselect_b32 s28, s29, s28
    v_mfma_f32_32x32x16_bf16 v[48:63], v[100:103], v[208:211], v[48:63]
    ds_read_b64_tr_b16 v[216:217], v7 offset:6144
    ds_read_b64_tr_b16 v[218:219], v7 offset:7168
    ds_read_b64_tr_b16 v[220:221], v8 offset:6144
    ds_read_b64_tr_b16 v[222:223], v8 offset:7168
    v_mfma_f32_32x32x16_bf16 v[32:47], v[96:99], v[212:215], v[32:47]
    v_mfma_f32_32x32x16_bf16 v[64:79], v[100:103], v[212:215], v[64:79]
    s_waitcnt vmcnt(4)
    s_waitcnt lgkmcnt(0)
    v_mfma_f32_32x32x16_bf16 v[16:31], v[104:107], v[216:219], v[16:31]
    buffer_load_dwordx4 v[96:99], v13, s[60:63], s28 offen sc1
    buffer_load_dwordx4 v[100:103], v14, s[60:63], s28 offen sc1
    s_add_u32 s28, s28, 2048
    s_cmp_eq_u32 s28, s30
    s_cselect_b32 s28, s29, s28
    v_mfma_f32_32x32x16_bf16 v[48:63], v[108:111], v[216:219], v[48:63]
    ds_read_b64_tr_b16 v[208:209], v7 offset:8192
    ds_read_b64_tr_b16 v[210:211], v7 offset:9216
    ds_read_b64_tr_b16 v[212:213], v8 offset:8192
    ds_read_b64_tr_b16 v[214:215], v8 offset:9216
    v_mfma_f32_32x32x16_bf16 v[32:47], v[104:107], v[220:223], v[32:47]
    v_mfma_f32_32x32x16_bf16 v[64:79], v[108:111], v[220:223], v[64:79]
    s_waitcnt vmcnt(4)
    s_waitcnt lgkmcnt(0)
    v_mfma_f32_32x32x16_bf16 v[16:31], v[80:83], v[208:211], v[16:31]
    buffer_load_dwordx4 v[104:107], v13, s[60:63], s28 offen sc1
    buffer_load_dwordx4 v[108:111], v14, s[60:63], s28 offen sc1
    s_add_u32 s28, s28, 2048
    s_cmp_eq_u32 s28, s30
    s_cselect_b32 s28, s29, s28
    v_mfma_f32_32x32x16_bf16 v[48:63], v[84:87], v[208:211], v[48:63]
    ds_read_b64_tr_b16 v[216:217], v7 offset:10240
    ds_read_b64_tr_b16 v[218:219], v7 offset:11264
    ds_read_b64_tr_b16 v[220:221], v8 offset:10240
    ds_read_b64_tr_b16 v[222:223], v8 offset:11264
    v_mfma_f32_32x32x16_bf16 v[32:47], v[80:83], v[212:215], v[32:47]
    v_mfma_f32_32x32x16_bf16 v[64:79], v[84:87], v[212:215], v[64:79]
    s_waitcnt vmcnt(4)
    s_waitcnt lgkmcnt(0)
    v_mfma_f32_32x32x16_bf16 v[16:31], v[88:91], v[216:219], v[16:31]
    s_mov_b64 exec, 1
    ds_add_u32 v247, v1 offset:20
    s_mov_b64 exec, -1
    buffer_load_dwordx4 v[80:83], v13, s[60:63], s28 offen sc1
    buffer_load_dwordx4 v[84:87], v14, s[60:63], s28 offen sc1
    s_add_u32 s28, s28, 2048
    s_cmp_eq_u32 s28, s30
    s_cselect_b32 s28, s29, s28
    v_mfma_f32_32x32x16_bf16 v[48:63], v[92:95], v[216:219], v[48:63]
    ds_read_b64_tr_b16 v[208:209], v7 offset:53248
    ds_read_b64_tr_b16 v[210:211], v7 offset:54272
    ds_read_b64_tr_b16 v[212:213], v8 offset:53248
    ds_read_b64_tr_b16 v[214:215], v8 offset:54272
    v_mfma_f32_32x32x16_bf16 v[32:47], v[88:91], v[220:223], v[32:47]
    v_mfma_f32_32x32x16_bf16 v[64:79], v[92:95], v[220:223], v[64:79]
    s_waitcnt vmcnt(4)
    s_waitcnt lgkmcnt(0)
    v_mfma_f32_32x32x16_bf16 v[16:31], v[96:99], v[208:211], v[16:31]
    buffer_load_dwordx4 v[88:91], v13, s[60:63], s28 offen sc1
    buffer_load_dwordx4 v[92:95], v14, s[60:63], s28 offen sc1
    s_add_u32 s28, s28, 2048
    s_cmp_eq_u32 s28, s30
    s_cselect_b32 s28, s29, s28
    v_mfma_f32_32x32x16_bf16 v[48:63], v[100:103], v[208:211], v[48:63]
    ds_read_b64_tr_b16 v[216:217], v7 offset:55296
    ds_read_b64_tr_b16 v[218:219], v7 offset:56320
    ds_read_b64_tr_b16 v[220:221], v8 offset:55296
    ds_read_b64_tr_b16 v[222:223], v8 offset:56320
    v_mfma_f32_32x32x16_bf16 v[32:47], v[96:99], v[212:215], v[32:47]
    v_mfma_f32_32x32x16_bf16 v[64:79], v[100:103], v[212:215], v[64:79]
    s_waitcnt vmcnt(4)
    s_waitcnt lgkmcnt(0)
    v_mfma_f32_32x32x16_bf16 v[16:31], v[104:107], v[216:219], v[16:31]
    buffer_load_dwordx4 v[96:99], v13, s[60:63], s28 offen sc1
    buffer_load_dwordx4 v[100:103], v14, s[60:63], s28 offen sc1
    s_add_u32 s28, s28, 2048
    s_cmp_eq_u32 s28, s30
    s_cselect_b32 s28, s29, s28
    v_mfma_f32_32x32x16_bf16 v[48:63], v[108:111], v[216:219], v[48:63]
    ds_read_b64_tr_b16 v[208:209], v7 offset:57344
    ds_read_b64_tr_b16 v[210:211], v7 offset:58368
    ds_read_b64_tr_b16 v[212:213], v8 offset:57344
    ds_read_b64_tr_b16 v[214:215], v8 offset:58368
    v_mfma_f32_32x32x16_bf16 v[32:47], v[104:107], v[220:223], v[32:47]
    s_add_u32 m0, s18, 49152
    s_add_u32 s8, s25, 31744
    buffer_load_dwordx4 v3, s[56:59], s25 offen lds
    buffer_load_dwordx4 v3, s[56:59], s8 offen offset:1024 lds
    s_add_u32 s25, s25, 65536
    s_cmp_eq_u32 s25, s27
    s_cselect_b32 s25, s26, s25
    v_mfma_f32_32x32x16_bf16 v[64:79], v[108:111], v[220:223], v[64:79]
    s_waitcnt vmcnt(6)
    s_waitcnt lgkmcnt(0)
    v_mfma_f32_32x32x16_bf16 v[16:31], v[80:83], v[208:211], v[16:31]
    buffer_load_dwordx4 v[104:107], v13, s[60:63], s28 offen sc1
    buffer_load_dwordx4 v[108:111], v14, s[60:63], s28 offen sc1
    s_add_u32 s28, s28, 2048
    s_cmp_eq_u32 s28, s30
    s_cselect_b32 s28, s29, s28
    v_mfma_f32_32x32x16_bf16 v[48:63], v[84:87], v[208:211], v[48:63]
    ds_read_b64_tr_b16 v[216:217], v7 offset:59392
    ds_read_b64_tr_b16 v[218:219], v7 offset:60416
    ds_read_b64_tr_b16 v[220:221], v8 offset:59392
    ds_read_b64_tr_b16 v[222:223], v8 offset:60416
    v_mfma_f32_32x32x16_bf16 v[32:47], v[80:83], v[212:215], v[32:47]
    s_add_u32 m0, s18, 51200
    s_add_u32 s8, s25, 31744
    buffer_load_dwordx4 v3, s[56:59], s25 offen lds
    buffer_load_dwordx4 v3, s[56:59], s8 offen offset:1024 lds
    s_add_u32 s25, s25, 65536
    s_cmp_eq_u32 s25, s27
    s_cselect_b32 s25, s26, s25
    v_mfma_f32_32x32x16_bf16 v[64:79], v[84:87], v[212:215], v[64:79]
    s_waitcnt vmcnt(8)
    s_waitcnt lgkmcnt(0)
    v_mfma_f32_32x32x16_bf16 v[16:31], v[88:91], v[216:219], v[16:31]
    buffer_load_dwordx4 v[80:83], v13, s[60:63], s28 offen sc1
    buffer_load_dwordx4 v[84:87], v14, s[60:63], s28 offen sc1
    s_add_u32 s28, s28, 2048
    s_cmp_eq_u32 s28, s30
    s_cselect_b32 s28, s29, s28
    v_mfma_f32_32x32x16_bf16 v[48:63], v[92:95], v[216:219], v[48:63]
    s_waitcnt vmcnt(6)
    ds_read_b64_tr_b16 v[208:209], v7 offset:49152
    ds_read_b64_tr_b16 v[210:211], v7 offset:50176
    ds_read_b64_tr_b16 v[212:213], v8 offset:49152
    ds_read_b64_tr_b16 v[214:215], v8 offset:50176
    v_mfma_f32_32x32x16_bf16 v[32:47], v[88:91], v[220:223], v[32:47]
    s_add_u32 m0, s18, 53248
    s_add_u32 s8, s25, 31744
    buffer_load_dwordx4 v3, s[56:59], s25 offen lds
    buffer_load_dwordx4 v3, s[56:59], s8 offen offset:1024 lds
    s_add_u32 s25, s25, 65536
    s_cmp_eq_u32 s25, s27
    s_cselect_b32 s25, s26, s25
    v_mfma_f32_32x32x16_bf16 v[64:79], v[92:95], v[220:223], v[64:79]
    s_waitcnt lgkmcnt(0)
    v_mfma_f32_32x32x16_bf16 v[16:31], v[96:99], v[208:211], v[16:31]
    buffer_load_dwordx4 v[88:91], v13, s[60:63], s28 offen sc1
    buffer_load_dwordx4 v[92:95], v14, s[60:63], s28 offen sc1
    s_add_u32 s28, s28, 2048
    s_cmp_eq_u32 s28, s30
    s_cselect_b32 s28, s29, s28
    v_mfma_f32_32x32x16_bf16 v[48:63], v[100:103], v[208:211], v[48:63]
    s_waitcnt vmcnt(6)
    ds_read_b64_tr_b16 v[216:217], v7 offset:51200
    ds_read_b64_tr_b16 v[218:219], v7 offset:52224
    ds_read_b64_tr_b16 v[220:221], v8 offset:51200
    ds_read_b64_tr_b16 v[222:223], v8 offset:52224
    v_mfma_f32_32x32x16_bf16 v[32:47], v[96:99], v[212:215], v[32:47]
    s_add_u32 m0, s18, 55296
    s_add_u32 s8, s25, 31744
    buffer_load_dwordx4 v3, s[56:59], s25 offen lds
    buffer_load_dwordx4 v3, s[56:59], s8 offen offset:1024 lds
    s_add_u32 s25, s25, 65536
    s_cmp_eq_u32 s25, s27
    s_cselect_b32 s25, s26, s25
    v_mfma_f32_32x32x16_bf16 v[64:79], v[100:103], v[212:215], v[64:79]
    s_waitcnt lgkmcnt(0)
    v_mfma_f32_32x32x16_bf16 v[16:31], v[104:107], v[216:219], v[16:31]
    buffer_load_dwordx4 v[96:99], v13, s[60:63], s28 offen sc1
    buffer_load_dwordx4 v[100:103], v14, s[60:63], s28 offen sc1
    s_add_u32 s28, s28, 2048
    s_cmp_eq_u32 s28, s30
    s_cselect_b32 s28, s29, s28
    v_mfma_f32_32x32x16_bf16 v[48:63], v[108:111], v[216:219], v[48:63]
    s_waitcnt vmcnt(6)
    ds_read_b64_tr_b16 v[208:209], v7 offset:53248
    ds_read_b64_tr_b16 v[210:211], v7 offset:54272
    ds_read_b64_tr_b16 v[212:213], v8 offset:53248
    ds_read_b64_tr_b16 v[214:215], v8 offset:54272
    v_mfma_f32_32x32x16_bf16 v[32:47], v[104:107], v[220:223], v[32:47]
    s_add_u32 m0, s18, 57344
    s_add_u32 s8, s25, 31744
    buffer_load_dwordx4 v3, s[56:59], s25 offen lds
    buffer_load_dwordx4 v3, s[56:59], s8 offen offset:1024 lds
    s_add_u32 s25, s25, 65536
    s_cmp_eq_u32 s25, s27
    s_cselect_b32 s25, s26, s25
    v_mfma_f32_32x32x16_bf16 v[64:79], v[108:111], v[220:223], v[64:79]
    s_waitcnt lgkmcnt(0)
    v_mfma_f32_32x32x16_bf16 v[16:31], v[80:83], v[208:211], v[16:31]
    buffer_load_dwordx4 v[104:107], v13, s[60:63], s28 offen sc1
    buffer_load_dwordx4 v[108:111], v14, s[60:63], s28 offen sc1
    s_add_u32 s28, s28, 2048
    s_cmp_eq_u32 s28, s30
    s_cselect_b32 s28, s29, s28
    v_mfma_f32_32x32x16_bf16 v[48:63], v[84:87], v[208:211], v[48:63]
    s_waitcnt vmcnt(6)
    ds_read_b64_tr_b16 v[216:217], v7 offset:55296
    ds_read_b64_tr_b16 v[218:219], v7 offset:56320
    ds_read_b64_tr_b16 v[220:221], v8 offset:55296
    ds_read_b64_tr_b16 v[222:223], v8 offset:56320
    v_mfma_f32_32x32x16_bf16 v[32:47], v[80:83], v[212:215], v[32:47]
    s_add_u32 m0, s18, 59392
    s_add_u32 s8, s25, 31744
    buffer_load_dwordx4 v3, s[56:59], s25 offen lds
    buffer_load_dwordx4 v3, s[56:59], s8 offen offset:1024 lds
    s_add_u32 s25, s25, 65536
    s_cmp_eq_u32 s25, s27
    s_cselect_b32 s25, s26, s25
    v_mfma_f32_32x32x16_bf16 v[64:79], v[84:87], v[212:215], v[64:79]
    s_waitcnt lgkmcnt(0)
    v_mfma_f32_32x32x16_bf16 v[16:31], v[88:91], v[216:219], v[16:31]
    buffer_load_dwordx4 v[80:83], v13, s[60:63], s28 offen sc1
    buffer_load_dwordx4 v[84:87], v14, s[60:63], s28 offen sc1
    s_add_u32 s28, s28, 2048
    s_cmp_eq_u32 s28, s30
    s_cselect_b32 s28, s29, s28
    v_mfma_f32_32x32x16_bf16 v[48:63], v[92:95], v[216:219], v[48:63]
    s_waitcnt vmcnt(6)
    ds_read_b64_tr_b16 v[208:209], v7 offset:57344
    ds_read_b64_tr_b16 v[210:211], v7 offset:58368
    ds_read_b64_tr_b16 v[212:213], v8 offset:57344
    ds_read_b64_tr_b16 v[214:215], v8 offset:58368
    v_mfma_f32_32x32x16_bf16 v[32:47], v[88:91], v[220:223], v[32:47]
    s_add_u32 m0, s18, 49152
    s_add_u32 s8, s25, 31744
    buffer_load_dwordx4 v3, s[56:59], s25 offen lds
    buffer_load_dwordx4 v3, s[56:59], s8 offen offset:1024 lds
    s_add_u32 s25, s25, 65536
    s_cmp_eq_u32 s25, s27
    s_cselect_b32 s25, s26, s25
    v_mfma_f32_32x32x16_bf16 v[64:79], v[92:95], v[220:223], v[64:79]
    s_waitcnt lgkmcnt(0)
    v_mfma_f32_32x32x16_bf16 v[16:31], v[96:99], v[208:211], v[16:31]
    buffer_load_dwordx4 v[88:91], v13, s[60:63], s28 offen sc1
    buffer_load_dwordx4 v[92:95], v14, s[60:63], s28 offen sc1
    s_add_u32 s28, s28, 2048
    s_cmp_eq_u32 s28, s30
    s_cselect_b32 s28, s29, s28
    v_mfma_f32_32x32x16_bf16 v[48:63], v[100:103], v[208:211], v[48:63]
    s_waitcnt vmcnt(6)
    ds_read_b64_tr_b16 v[216:217], v7 offset:59392
    ds_read_b64_tr_b16 v[218:219], v7 offset:60416
    ds_read_b64_tr_b16 v[220:221], v8 offset:59392
    ds_read_b64_tr_b16 v[222:223], v8 offset:60416
    v_mfma_f32_32x32x16_bf16 v[32:47], v[96:99], v[212:215], v[32:47]
    s_add_u32 m0, s18, 51200
    s_add_u32 s8, s25, 31744
    buffer_load_dwordx4 v3, s[56:59], s25 offen lds
    buffer_load_dwordx4 v3, s[56:59], s8 offen offset:1024 lds
    s_add_u32 s25, s25, 65536
    s_cmp_eq_u32 s25, s27
    s_cselect_b32 s25, s26, s25
    v_mfma_f32_32x32x16_bf16 v[64:79], v[100:103], v[212:215], v[64:79]
    s_waitcnt lgkmcnt(0)
    v_mfma_f32_32x32x16_bf16 v[16:31], v[104:107], v[216:219], v[16:31]
    buffer_load_dwordx4 v[96:99], v13, s[60:63], s28 offen sc1
    buffer_load_dwordx4 v[100:103], v14, s[60:63], s28 offen sc1
    s_add_u32 s28, s28, 2048
    s_cmp_eq_u32 s28, s30
    s_cselect_b32 s28, s29, s28
    v_mfma_f32_32x32x16_bf16 v[48:63], v[108:111], v[216:219], v[48:63]
    s_waitcnt vmcnt(6)
    ds_read_b64_tr_b16 v[208:209], v7 offset:49152
    ds_read_b64_tr_b16 v[210:211], v7 offset:50176
    ds_read_b64_tr_b16 v[212:213], v8 offset:49152
    ds_read_b64_tr_b16 v[214:215], v8 offset:50176
    v_mfma_f32_32x32x16_bf16 v[32:47], v[104:107], v[220:223], v[32:47]
    s_add_u32 m0, s18, 53248
    s_add_u32 s8, s25, 31744
    buffer_load_dwordx4 v3, s[56:59], s25 offen lds
    buffer_load_dwordx4 v3, s[56:59], s8 offen offset:1024 lds
    s_add_u32 s25, s25, 65536
    s_cmp_eq_u32 s25, s27
    s_cselect_b32 s25, s26, s25
    v_mfma_f32_32x32x16_bf16 v[64:79], v[108:111], v[220:223], v[64:79]
    s_waitcnt lgkmcnt(0)
    v_mfma_f32_32x32x16_bf16 v[16:31], v[80:83], v[208:211], v[16:31]
    buffer_load_dwordx4 v[104:107], v13, s[60:63], s28 offen sc1
    buffer_load_dwordx4 v[108:111], v14, s[60:63], s28 offen sc1
    s_add_u32 s28, s28, 2048
    s_cmp_eq_u32 s28, s30
    s_cselect_b32 s28, s29, s28
    v_mfma_f32_32x32x16_bf16 v[48:63], v[84:87], v[208:211], v[48:63]
    s_waitcnt vmcnt(6)
    ds_read_b64_tr_b16 v[216:217], v7 offset:51200
    ds_read_b64_tr_b16 v[218:219], v7 offset:52224
    ds_read_b64_tr_b16 v[220:221], v8 offset:51200
    ds_read_b64_tr_b16 v[222:223], v8 offset:52224
    v_mfma_f32_32x32x16_bf16 v[32:47], v[80:83], v[212:215], v[32:47]
    s_add_u32 m0, s18, 55296
    s_add_u32 s8, s25, 31744
    buffer_load_dwordx4 v3, s[56:59], s25 offen lds
    buffer_load_dwordx4 v3, s[56:59], s8 offen offset:1024 lds
    s_add_u32 s25, s25, 65536
    s_cmp_eq_u32 s25, s27
    s_cselect_b32 s25, s26, s25
    v_mfma_f32_32x32x16_bf16 v[64:79], v[84:87], v[212:215], v[64:79]
    s_waitcnt lgkmcnt(0)
    v_mfma_f32_32x32x16_bf16 v[16:31], v[88:91], v[216:219], v[16:31]
    buffer_load_dwordx4 v[80:83], v13, s[60:63], s28 offen sc1
    buffer_load_dwordx4 v[84:87], v14, s[60:63], s28 offen sc1
    s_add_u32 s28, s28, 2048
    s_cmp_eq_u32 s28, s30
    s_cselect_b32 s28, s29, s28
    v_mfma_f32_32x32x16_bf16 v[48:63], v[92:95], v[216:219], v[48:63]
    s_waitcnt vmcnt(6)
    ds_read_b64_tr_b16 v[208:209], v7 offset:53248
    ds_read_b64_tr_b16 v[210:211], v7 offset:54272
    ds_read_b64_tr_b16 v[212:213], v8 offset:53248
    ds_read_b64_tr_b16 v[214:215], v8 offset:54272
    v_mfma_f32_32x32x16_bf16 v[32:47], v[88:91], v[220:223], v[32:47]
    s_add_u32 m0, s18, 57344
    s_add_u32 s8, s25, 31744
    buffer_load_dwordx4 v3, s[56:59], s25 offen lds
    buffer_load_dwordx4 v3, s[56:59], s8 offen offset:1024 lds
    s_add_u32 s25, s25, 65536
    s_cmp_eq_u32 s25, s27
    s_cselect_b32 s25, s26, s25
    v_mfma_f32_32x32x16_bf16 v[64:79], v[92:95], v[220:223], v[64:79]
    s_waitcnt lgkmcnt(0)
    v_mfma_f32_32x32x16_bf16 v[16:31], v[96:99], v[208:211], v[16:31]
    buffer_load_dwordx4 v[88:91], v13, s[60:63], s28 offen sc1
    buffer_load_dwordx4 v[92:95], v14, s[60:63], s28 offen sc1
    s_add_u32 s28, s28, 2048
    s_cmp_eq_u32 s28, s30
    s_cselect_b32 s28, s29, s28
    v_mfma_f32_32x32x16_bf16 v[48:63], v[100:103], v[208:211], v[48:63]
    s_waitcnt vmcnt(6)
    ds_read_b64_tr_b16 v[216:217], v7 offset:55296
    ds_read_b64_tr_b16 v[218:219], v7 offset:56320
    ds_read_b64_tr_b16 v[220:221], v8 offset:55296
    ds_read_b64_tr_b16 v[222:223], v8 offset:56320
    v_mfma_f32_32x32x16_bf16 v[32:47], v[96:99], v[212:215], v[32:47]
    s_add_u32 m0, s18, 59392
    s_add_u32 s8, s25, 31744
    buffer_load_dwordx4 v3, s[56:59], s25 offen lds
    buffer_load_dwordx4 v3, s[56:59], s8 offen offset:1024 lds
    s_add_u32 s25, s25, 65536
    s_cmp_eq_u32 s25, s27
    s_cselect_b32 s25, s26, s25
    v_mfma_f32_32x32x16_bf16 v[64:79], v[100:103], v[212:215], v[64:79]
    s_waitcnt lgkmcnt(0)
    v_mfma_f32_32x32x16_bf16 v[16:31], v[104:107], v[216:219], v[16:31]
    buffer_load_dwordx4 v[96:99], v13, s[60:63], s28 offen sc1
    buffer_load_dwordx4 v[100:103], v14, s[60:63], s28 offen sc1
    s_add_u32 s28, s28, 2048
    s_cmp_eq_u32 s28, s30
    s_cselect_b32 s28, s29, s28
    v_mfma_f32_32x32x16_bf16 v[48:63], v[108:111], v[216:219], v[48:63]
    s_waitcnt vmcnt(6)
    ds_read_b64_tr_b16 v[208:209], v7 offset:57344
    ds_read_b64_tr_b16 v[210:211], v7 offset:58368
    ds_read_b64_tr_b16 v[212:213], v8 offset:57344
    ds_read_b64_tr_b16 v[214:215], v8 offset:58368
    v_mfma_f32_32x32x16_bf16 v[32:47], v[104:107], v[220:223], v[32:47]
    s_add_u32 m0, s18, 49152
    s_add_u32 s8, s25, 31744
    buffer_load_dwordx4 v3, s[56:59], s25 offen lds
    buffer_load_dwordx4 v3, s[56:59], s8 offen offset:1024 lds
    s_add_u32 s25, s25, 65536
    s_cmp_eq_u32 s25, s27
    s_cselect_b32 s25, s26, s25
    v_mfma_f32_32x32x16_bf16 v[64:79], v[108:111], v[220:223], v[64:79]
    s_waitcnt lgkmcnt(0)
    v_mfma_f32_32x32x16_bf16 v[16:31], v[80:83], v[208:211], v[16:31]
    buffer_load_dwordx4 v[104:107], v13, s[60:63], s28 offen sc1
    buffer_load_dwordx4 v[108:111], v14, s[60:63], s28 offen sc1
    s_add_u32 s28, s28, 2048
    s_cmp_eq_u32 s28, s30
    s_cselect_b32 s28, s29, s28
    v_mfma_f32_32x32x16_bf16 v[48:63], v[84:87], v[208:211], v[48:63]
    s_waitcnt vmcnt(6)
    ds_read_b64_tr_b16 v[216:217], v7 offset:59392
    ds_read_b64_tr_b16 v[218:219], v7 offset:60416
    ds_read_b64_tr_b16 v[220:221], v8 offset:59392
    ds_read_b64_tr_b16 v[222:223], v8 offset:60416
    v_mfma_f32_32x32x16_bf16 v[32:47], v[80:83], v[212:215], v[32:47]
    s_add_u32 m0, s18, 51200
    s_add_u32 s8, s25, 31744
    buffer_load_dwordx4 v3, s[56:59], s25 offen lds
    buffer_load_dwordx4 v3, s[56:59], s8 offen offset:1024 lds
    s_add_u32 s25, s25, 65536
    s_cmp_eq_u32 s25, s27
    s_cselect_b32 s25, s26, s25
    v_mfma_f32_32x32x16_bf16 v[64:79], v[84:87], v[212:215], v[64:79]
    s_waitcnt lgkmcnt(0)
    v_mfma_f32_32x32x16_bf16 v[16:31], v[88:91], v[216:219], v[16:31]
    buffer_load_dwordx4 v[80:83], v13, s[60:63], s28 offen sc1
    buffer_load_dwordx4 v[84:87], v14, s[60:63], s28 offen sc1
    s_add_u32 s28, s28, 2048
    s_cmp_eq_u32 s28, s30
    s_cselect_b32 s28, s29, s28
    v_mfma_f32_32x32x16_bf16 v[48:63], v[92:95], v[216:219], v[48:63]
    s_waitcnt vmcnt(6)
    ds_read_b64_tr_b16 v[208:209], v7 offset:49152
    ds_read_b64_tr_b16 v[210:211], v7 offset:50176
    ds_read_b64_tr_b16 v[212:213], v8 offset:49152
    ds_read_b64_tr_b16 v[214:215], v8 offset:50176
    v_mfma_f32_32x32x16_bf16 v[32:47], v[88:91], v[220:223], v[32:47]
    s_add_u32 m0, s18, 53248
    s_add_u32 s8, s25, 31744
    buffer_load_dwordx4 v3, s[56:59], s25 offen lds
    buffer_load_dwordx4 v3, s[56:59], s8 offen offset:1024 lds
    s_add_u32 s25, s25, 65536
    s_cmp_eq_u32 s25, s27
    s_cselect_b32 s25, s26, s25
    v_mfma_f32_32x32x16_bf16 v[64:79], v[92:95], v[220:223], v[64:79]
    s_waitcnt lgkmcnt(0)
    v_mfma_f32_32x32x16_bf16 v[16:31], v[96:99], v[208:211], v[16:31]
    buffer_load_dwordx4 v[88:91], v13, s[60:63], s28 offen sc1
    buffer_load_dwordx4 v[92:95], v14, s[60:63], s28 offen sc1
    s_add_u32 s28, s28, 2048
    s_cmp_eq_u32 s28, s30
    s_cselect_b32 s28, s29, s28
    v_mfma_f32_32x32x16_bf16 v[48:63], v[100:103], v[208:211], v[48:63]
    s_waitcnt vmcnt(6)
    ds_read_b64_tr_b16 v[216:217], v7 offset:51200
    ds_read_b64_tr_b16 v[218:219], v7 offset:52224
    ds_read_b64_tr_b16 v[220:221], v8 offset:51200
    ds_read_b64_tr_b16 v[222:223], v8 offset:52224
    v_mfma_f32_32x32x16_bf16 v[32:47], v[96:99], v[212:215], v[32:47]
    s_add_u32 m0, s18, 55296
    s_add_u32 s8, s25, 31744
    buffer_load_dwordx4 v3, s[56:59], s25 offen lds
    buffer_load_dwordx4 v3, s[56:59], s8 offen offset:1024 lds
    s_add_u32 s25, s25, 65536
    s_cmp_eq_u32 s25, s27
    s_cselect_b32 s25, s26, s25
    v_mfma_f32_32x32x16_bf16 v[64:79], v[100:103], v[212:215], v[64:79]
    s_waitcnt lgkmcnt(0)
    v_mfma_f32_32x32x16_bf16 v[16:31], v[104:107], v[216:219], v[16:31]
    buffer_load_dwordx4 v[96:99], v13, s[60:63], s28 offen sc1
    buffer_load_dwordx4 v[100:103], v14, s[60:63], s28 offen sc1
    s_add_u32 s28, s28, 2048
    s_cmp_eq_u32 s28, s30
    s_cselect_b32 s28, s29, s28
    v_mfma_f32_32x32x16_bf16 v[48:63], v[108:111], v[216:219], v[48:63]
    s_waitcnt vmcnt(6)
    ds_read_b64_tr_b16 v[208:209], v7 offset:53248
    ds_read_b64_tr_b16 v[210:211], v7 offset:54272
    ds_read_b64_tr_b16 v[212:213], v8 offset:53248
    ds_read_b64_tr_b16 v[214:215], v8 offset:54272
    v_mfma_f32_32x32x16_bf16 v[32:47], v[104:107], v[220:223], v[32:47]
    s_add_u32 m0, s18, 57344
    s_add_u32 s8, s25, 31744
    buffer_load_dwordx4 v3, s[56:59], s25 offen lds
    buffer_load_dwordx4 v3, s[56:59], s8 offen offset:1024 lds
    s_add_u32 s25, s25, 65536
    s_cmp_eq_u32 s25, s27
    s_cselect_b32 s25, s26, s25
    v_mfma_f32_32x32x16_bf16 v[64:79], v[108:111], v[220:223], v[64:79]
    s_waitcnt lgkmcnt(0)
    v_mfma_f32_32x32x16_bf16 v[16:31], v[80:83], v[208:211], v[16:31]
    buffer_load_dwordx4 v[104:107], v13, s[60:63], s28 offen sc1
    buffer_load_dwordx4 v[108:111], v14, s[60:63], s28 offen sc1
    s_add_u32 s28, s28, 2048
    s_cmp_eq_u32 s28, s30
    s_cselect_b32 s28, s29, s28
    v_mfma_f32_32x32x16_bf16 v[48:63], v[84:87], v[208:211], v[48:63]
    s_waitcnt vmcnt(6)
    ds_read_b64_tr_b16 v[216:217], v7 offset:55296
    ds_read_b64_tr_b16 v[218:219], v7 offset:56320
    ds_read_b64_tr_b16 v[220:221], v8 offset:55296
    ds_read_b64_tr_b16 v[222:223], v8 offset:56320
    v_mfma_f32_32x32x16_bf16 v[32:47], v[80:83], v[212:215], v[32:47]
    s_add_u32 m0, s18, 59392
    s_add_u32 s8, s25, 31744
    buffer_load_dwordx4 v3, s[56:59], s25 offen lds
    buffer_load_dwordx4 v3, s[56:59], s8 offen offset:1024 lds
    s_add_u32 s25, s25, 65536
    s_cmp_eq_u32 s25, s27
    s_cselect_b32 s25, s26, s25
    v_mfma_f32_32x32x16_bf16 v[64:79], v[84:87], v[212:215], v[64:79]
    s_waitcnt lgkmcnt(0)
    v_mfma_f32_32x32x16_bf16 v[16:31], v[88:91], v[216:219], v[16:31]
    v_mfma_f32_32x32x16_bf16 v[48:63], v[92:95], v[216:219], v[48:63]
    s_waitcnt vmcnt(4)
    ds_read_b64_tr_b16 v[208:209], v7 offset:57344
    ds_read_b64_tr_b16 v[210:211], v7 offset:58368
    ds_read_b64_tr_b16 v[212:213], v8 offset:57344
    ds_read_b64_tr_b16 v[214:215], v8 offset:58368
    v_mfma_f32_32x32x16_bf16 v[32:47], v[88:91], v[220:223], v[32:47]
    v_mfma_f32_32x32x16_bf16 v[64:79], v[92:95], v[220:223], v[64:79]
    s_waitcnt lgkmcnt(0)
    v_mfma_f32_32x32x16_bf16 v[16:31], v[96:99], v[208:211], v[16:31]
    v_mfma_f32_32x32x16_bf16 v[48:63], v[100:103], v[208:211], v[48:63]
    s_waitcnt vmcnt(0)
    ds_read_b64_tr_b16 v[216:217], v7 offset:59392
    ds_read_b64_tr_b16 v[218:219], v7 offset:60416
    ds_read_b64_tr_b16 v[220:221], v8 offset:59392
    ds_read_b64_tr_b16 v[222:223], v8 offset:60416
    v_mfma_f32_32x32x16_bf16 v[32:47], v[96:99], v[212:215], v[32:47]
    v_mfma_f32_32x32x16_bf16 v[64:79], v[100:103], v[212:215], v[64:79]
    s_waitcnt lgkmcnt(0)
    v_mfma_f32_32x32x16_bf16 v[16:31], v[104:107], v[216:219], v[16:31]
    v_mfma_f32_32x32x16_bf16 v[48:63], v[108:111], v[216:219], v[48:63]
    v_mfma_f32_32x32x16_bf16 v[32:47], v[104:107], v[220:223], v[32:47]
    v_mfma_f32_32x32x16_bf16 v[64:79], v[108:111], v[220:223], v[64:79]
    s_setprio 3
    buffer_load_dwordx2 v[230:231], v228, s[60:63], s33 offen sc1
    v_sub_f32 v224, 1.0, v224
    v_mov_b32 v225, v224
    v_sub_f32 v226, 1.0, v226
    v_mov_b32 v227, v226
    s_nop 4
    v_pk_mul_f32 v[16:17], v[16:17], v[224:225]
    v_pk_mul_f32 v[18:19], v[18:19], v[224:225]
    v_pk_mul_f32 v[20:21], v[20:21], v[224:225]
    v_pk_mul_f32 v[22:23], v[22:23], v[224:225]
    v_pk_mul_f32 v[24:25], v[24:25], v[224:225]
    v_pk_mul_f32 v[26:27], v[26:27], v[224:225]
    v_pk_mul_f32 v[28:29], v[28:29], v[224:225]
    v_pk_mul_f32 v[30:31], v[30:31], v[224:225]
    v_pk_mul_f32 v[48:49], v[48:49], v[224:225]
    v_pk_mul_f32 v[50:51], v[50:51], v[224:225]
    v_pk_mul_f32 v[52:53], v[52:53], v[224:225]
    v_pk_mul_f32 v[54:55], v[54:55], v[224:225]
    v_pk_mul_f32 v[56:57], v[56:57], v[224:225]
    v_pk_mul_f32 v[58:59], v[58:59], v[224:225]
    v_pk_mul_f32 v[60:61], v[60:61], v[224:225]
    v_pk_mul_f32 v[62:63], v[62:63], v[224:225]
    v_pk_mul_f32 v[32:33], v[32:33], v[226:227]
    v_pk_mul_f32 v[34:35], v[34:35], v[226:227]
    v_pk_mul_f32 v[36:37], v[36:37], v[226:227]
    v_pk_mul_f32 v[38:39], v[38:39], v[226:227]
    v_pk_mul_f32 v[40:41], v[40:41], v[226:227]
    v_pk_mul_f32 v[42:43], v[42:43], v[226:227]
    v_pk_mul_f32 v[44:45], v[44:45], v[226:227]
    v_pk_mul_f32 v[46:47], v[46:47], v[226:227]
    v_pk_mul_f32 v[64:65], v[64:65], v[226:227]
    v_pk_mul_f32 v[66:67], v[66:67], v[226:227]
    v_pk_mul_f32 v[68:69], v[68:69], v[226:227]
    v_pk_mul_f32 v[70:71], v[70:71], v[226:227]
    v_pk_mul_f32 v[72:73], v[72:73], v[226:227]
    v_pk_mul_f32 v[74:75], v[74:75], v[226:227]
    v_pk_mul_f32 v[76:77], v[76:77], v[226:227]
    v_pk_mul_f32 v[78:79], v[78:79], v[226:227]
    s_waitcnt vmcnt(0)
    v_cmp_ne_u64 vcc, s[14:15], v[230:231]
    s_mov_b32 s26, vcc_lo
    s_bitcmp0_b32 s26, 0
    s_cbranch_scc1 L_opok_57
    s_mov_b32 s17, 200000
L_op_56:
    buffer_load_dwordx2 v[230:231], v228, s[60:63], s33 offen sc1
    s_waitcnt vmcnt(0)
    v_cmp_ne_u64 vcc, s[14:15], v[230:231]
    s_mov_b32 s26, vcc_lo
    s_bitcmp0_b32 s26, 0
    s_cbranch_scc1 L_opok_57
    s_sub_u32 s17, s17, 1
    s_cmp_lg_u32 s17, 0
    s_cbranch_scc1 L_op_56
    s_endpgm
L_opok_57:
    buffer_load_dwordx4 v[80:83], v11, s[60:63], s32 offen offset:0 sc1
    buffer_load_dwordx4 v[84:87], v12, s[60:63], s32 offen offset:0 sc1
    s_bitcmp0_b32 s26, 1
    s_cbranch_scc1 L_opok_59
    s_mov_b32 s17, 200000
L_op_58:
    buffer_load_dwordx2 v[230:231], v228, s[60:63], s33 offen sc1
    s_waitcnt vmcnt(0)
    v_cmp_ne_u64 vcc, s[14:15], v[230:231]
    s_mov_b32 s26, vcc_lo
    s_bitcmp0_b32 s26, 1
    s_cbranch_scc1 L_opok_59
    s_sub_u32 s17, s17, 1
    s_cmp_lg_u32 s17, 0
    s_cbranch_scc1 L_op_58
    s_endpgm
L_opok_59:
    buffer_load_dwordx4 v[88:91], v11, s[60:63], s32 offen offset:2048 sc1
    buffer_load_dwordx4 v[92:95], v12, s[60:63], s32 offen offset:2048 sc1
    s_bitcmp0_b32 s26, 2
    s_cbranch_scc1 L_opok_61
    s_mov_b32 s17, 200000
L_op_60:
    buffer_load_dwordx2 v[230:231], v228, s[60:63], s33 offen sc1
    s_waitcnt vmcnt(0)
    v_cmp_ne_u64 vcc, s[14:15], v[230:231]
    s_mov_b32 s26, vcc_lo
    s_bitcmp0_b32 s26, 2
    s_cbranch_scc1 L_opok_61
    s_sub_u32 s17, s17, 1
    s_cmp_lg_u32 s17, 0
    s_cbranch_scc1 L_op_60
    s_endpgm
L_opok_61:
    s_add_u32 s32, s32, 4096
    buffer_load_dwordx4 v[96:99], v11, s[60:63], s32 offen offset:0 sc1
    buffer_load_dwordx4 v[100:103], v12, s[60:63], s32 offen offset:0 sc1
    s_bitcmp0_b32 s26, 3
    s_cbranch_scc1 L_opok_63
    s_mov_b32 s17, 200000
L_op_62:
    buffer_load_dwordx2 v[230:231], v228, s[60:63], s33 offen sc1
    s_waitcnt vmcnt(0)
    v_cmp_ne_u64 vcc, s[14:15], v[230:231]
    s_mov_b32 s26, vcc_lo
    s_bitcmp0_b32 s26, 3
    s_cbranch_scc1 L_opok_63
    s_sub_u32 s17, s17, 1
    s_cmp_lg_u32 s17, 0
    s_cbranch_scc1 L_op_62
    s_endpgm
L_opok_63:
    buffer_load_dwordx4 v[104:107], v11, s[60:63], s32 offen offset:2048 sc1
    buffer_load_dwordx4 v[108:111], v12, s[60:63], s32 offen offset:2048 sc1
    s_bitcmp0_b32 s26, 4
    s_cbranch_scc1 L_opok_65
    s_mov_b32 s17, 200000
L_op_64:
    buffer_load_dwordx2 v[230:231], v228, s[60:63], s33 offen sc1
    s_waitcnt vmcnt(0)
    v_cmp_ne_u64 vcc, s[14:15], v[230:231]
    s_mov_b32 s26, vcc_lo
    s_bitcmp0_b32 s26, 4
    s_cbranch_scc1 L_opok_65
    s_sub_u32 s17, s17, 1
    s_cmp_lg_u32 s17, 0
    s_cbranch_scc1 L_op_64
    s_endpgm
L_opok_65:
    s_add_u32 s32, s32, 4096
    buffer_load_dwordx4 v[112:115], v11, s[60:63], s32 offen offset:0 sc1
    buffer_load_dwordx4 v[116:119], v12, s[60:63], s32 offen offset:0 sc1
    s_bitcmp0_b32 s26, 5
    s_cbranch_scc1 L_opok_67
    s_mov_b32 s17, 200000
L_op_66:
    buffer_load_dwordx2 v[230:231], v228, s[60:63], s33 offen sc1
    s_waitcnt vmcnt(0)
    v_cmp_ne_u64 vcc, s[14:15], v[230:231]
    s_mov_b32 s26, vcc_lo
    s_bitcmp0_b32 s26, 5
    s_cbranch_scc1 L_opok_67
    s_sub_u32 s17, s17, 1
    s_cmp_lg_u32 s17, 0
    s_cbranch_scc1 L_op_66
    s_endpgm
L_opok_67:
    buffer_load_dwordx4 v[120:123], v11, s[60:63], s32 offen offset:2048 sc1
    buffer_load_dwordx4 v[124:127], v12, s[60:63], s32 offen offset:2048 sc1
    s_waitcnt vmcnt(10)
    v_mfma_f32_32x32x16_bf16 v[32:47], v[144:147], v[84:87], v[32:47]
    v_mfma_f32_32x32x16_bf16 v[48:63], v[148:151], v[80:83], v[48:63]
    v_mfma_f32_32x32x16_bf16 v[64:79], v[148:151], v[84:87], v[64:79]
    v_mfma_f32_32x32x16_bf16 v[16:31], v[144:147], v[80:83], v[16:31]
    s_bitcmp0_b32 s26, 6
    s_cbranch_scc1 L_opok_69
    s_mov_b32 s17, 200000
L_op_68:
    buffer_load_dwordx2 v[230:231], v228, s[60:63], s33 offen sc1
    s_waitcnt vmcnt(0)
    v_cmp_ne_u64 vcc, s[14:15], v[230:231]
    s_mov_b32 s26, vcc_lo
    s_bitcmp0_b32 s26, 6
    s_cbranch_scc1 L_opok_69
    s_sub_u32 s17, s17, 1
    s_cmp_lg_u32 s17, 0
    s_cbranch_scc1 L_op_68
    s_endpgm
L_opok_69:
    s_add_u32 s32, s32, 4096
    buffer_load_dwordx4 v[128:131], v11, s[60:63], s32 offen offset:0 sc1
    buffer_load_dwordx4 v[132:135], v12, s[60:63], s32 offen offset:0 sc1
    s_waitcnt vmcnt(10)
    v_mfma_f32_32x32x16_bf16 v[32:47], v[152:155], v[92:95], v[32:47]
    v_mfma_f32_32x32x16_bf16 v[48:63], v[156:159], v[88:91], v[48:63]
    v_mfma_f32_32x32x16_bf16 v[64:79], v[156:159], v[92:95], v[64:79]
    v_mfma_f32_32x32x16_bf16 v[16:31], v[152:155], v[88:91], v[16:31]
    s_bitcmp0_b32 s26, 7
    s_cbranch_scc1 L_opok_71
    s_mov_b32 s17, 200000
L_op_70:
    buffer_load_dwordx2 v[230:231], v228, s[60:63], s33 offen sc1
    s_waitcnt vmcnt(0)
    v_cmp_ne_u64 vcc, s[14:15], v[230:231]
    s_mov_b32 s26, vcc_lo
    s_bitcmp0_b32 s26, 7
    s_cbranch_scc1 L_opok_71
    s_sub_u32 s17, s17, 1
    s_cmp_lg_u32 s17, 0
    s_cbranch_scc1 L_op_70
    s_endpgm
L_opok_71:
    buffer_load_dwordx4 v[136:139], v11, s[60:63], s32 offen offset:2048 sc1
    buffer_load_dwordx4 v[140:143], v12, s[60:63], s32 offen offset:2048 sc1
    s_waitcnt vmcnt(10)
    v_mfma_f32_32x32x16_bf16 v[32:47], v[160:163], v[100:103], v[32:47]
    v_mfma_f32_32x32x16_bf16 v[48:63], v[164:167], v[96:99], v[48:63]
    v_mfma_f32_32x32x16_bf16 v[64:79], v[164:167], v[100:103], v[64:79]
    v_mfma_f32_32x32x16_bf16 v[16:31], v[160:163], v[96:99], v[16:31]
    s_waitcnt vmcnt(8)
    v_mfma_f32_32x32x16_bf16 v[32:47], v[168:171], v[108:111], v[32:47]
    v_mfma_f32_32x32x16_bf16 v[48:63], v[172:175], v[104:107], v[48:63]
    v_mfma_f32_32x32x16_bf16 v[64:79], v[172:175], v[108:111], v[64:79]
    v_mfma_f32_32x32x16_bf16 v[16:31], v[168:171], v[104:107], v[16:31]
    s_waitcnt vmcnt(6)
    v_mfma_f32_32x32x16_bf16 v[32:47], v[176:179], v[116:119], v[32:47]
    v_mfma_f32_32x32x16_bf16 v[48:63], v[180:183], v[112:115], v[48:63]
    v_mfma_f32_32x32x16_bf16 v[64:79], v[180:183], v[116:119], v[64:79]
    v_mfma_f32_32x32x16_bf16 v[16:31], v[176:179], v[112:115], v[16:31]
    s_waitcnt vmcnt(4)
    v_mfma_f32_32x32x16_bf16 v[32:47], v[184:187], v[124:127], v[32:47]
    v_mfma_f32_32x32x16_bf16 v[48:63], v[188:191], v[120:123], v[48:63]
    v_mfma_f32_32x32x16_bf16 v[64:79], v[188:191], v[124:127], v[64:79]
    v_mfma_f32_32x32x16_bf16 v[16:31], v[184:187], v[120:123], v[16:31]
    s_waitcnt vmcnt(2)
    v_mfma_f32_32x32x16_bf16 v[32:47], v[192:195], v[132:135], v[32:47]
    v_mfma_f32_32x32x16_bf16 v[48:63], v[196:199], v[128:131], v[48:63]
    v_mfma_f32_32x32x16_bf16 v[64:79], v[196:199], v[132:135], v[64:79]
    v_mfma_f32_32x32x16_bf16 v[16:31], v[192:195], v[128:131], v[16:31]
    s_waitcnt vmcnt(0)
    v_mfma_f32_32x32x16_bf16 v[32:47], v[200:203], v[140:143], v[32:47]
    v_mfma_f32_32x32x16_bf16 v[48:63], v[204:207], v[136:139], v[48:63]
    v_mfma_f32_32x32x16_bf16 v[64:79], v[204:207], v[140:143], v[64:79]
    v_mfma_f32_32x32x16_bf16 v[16:31], v[200:203], v[136:139], v[16:31]
    v_mov_b32 v244, 156436
    s_mov_b32 s17, 1600000
L_sy_72:
    ds_read_b32 v245, v244
    s_waitcnt lgkmcnt(0)
    v_readfirstlane_b32 s8, v245
    s_cmp_ge_u32 s8, 4
    s_cbranch_scc1 L_syd_73
    s_sleep 1
    s_sub_u32 s17, s17, 1
    s_cmp_lg_u32 s17, 0
    s_cbranch_scc1 L_sy_72
    s_endpgm
L_syd_73:
    s_nop 2
    ds_write_b128 v241, v[32:35] offset:0
    ds_write_b128 v241, v[36:39] offset:1024
    ds_write_b128 v241, v[40:43] offset:2048
    ds_write_b128 v241, v[44:47] offset:3072
    ds_write_b128 v242, v[48:51] offset:0
    ds_write_b128 v242, v[52:55] offset:1024
    ds_write_b128 v242, v[56:59] offset:2048
    ds_write_b128 v242, v[60:63] offset:3072
    ds_write_b128 v243, v[64:67] offset:0
    ds_write_b128 v243, v[68:71] offset:1024
    ds_write_b128 v243, v[72:75] offset:2048
    ds_write_b128 v243, v[76:79] offset:3072
    s_waitcnt lgkmcnt(0)
    v_mov_b32 v244, 156448
    s_mov_b64 exec, 1
    ds_add_u32 v244, v1
    s_mov_b64 exec, -1
    v_mov_b32 v244, 156448
    s_mov_b32 s17, 1600000
L_sy_74:
    ds_read_b32 v245, v244
    s_waitcnt lgkmcnt(0)
    v_readfirstlane_b32 s8, v245
    s_cmp_ge_u32 s8, 4
    s_cbranch_scc1 L_syd_75
    s_sub_u32 s17, s17, 1
    s_cmp_lg_u32 s17, 0
    s_cbranch_scc1 L_sy_74
    s_endpgm
L_syd_75:
    ds_read_b128 v[32:35], v240 offset:0
    ds_read_b128 v[36:39], v240 offset:1024
    ds_read_b128 v[40:43], v240 offset:2048
    ds_read_b128 v[44:47], v240 offset:3072
    ds_read_b128 v[48:51], v240 offset:4096
    ds_read_b128 v[52:55], v240 offset:5120
    ds_read_b128 v[56:59], v240 offset:6144
    ds_read_b128 v[60:63], v240 offset:7168
    ds_read_b128 v[64:67], v240 offset:8192
    ds_read_b128 v[68:71], v240 offset:9216
    ds_read_b128 v[72:75], v240 offset:10240
    ds_read_b128 v[76:79], v240 offset:11264
    s_waitcnt lgkmcnt(8)
    v_pk_add_f32 v[16:17], v[16:17], v[32:33]
    v_pk_add_f32 v[18:19], v[18:19], v[34:35]
    v_pk_add_f32 v[20:21], v[20:21], v[36:37]
    v_pk_add_f32 v[22:23], v[22:23], v[38:39]
    v_pk_add_f32 v[24:25], v[24:25], v[40:41]
    v_pk_add_f32 v[26:27], v[26:27], v[42:43]
    v_pk_add_f32 v[28:29], v[28:29], v[44:45]
    v_pk_add_f32 v[30:31], v[30:31], v[46:47]
    s_waitcnt lgkmcnt(4)
    v_pk_add_f32 v[16:17], v[16:17], v[48:49]
    v_pk_add_f32 v[18:19], v[18:19], v[50:51]
    v_pk_add_f32 v[20:21], v[20:21], v[52:53]
    v_pk_add_f32 v[22:23], v[22:23], v[54:55]
    v_pk_add_f32 v[24:25], v[24:25], v[56:57]
    v_pk_add_f32 v[26:27], v[26:27], v[58:59]
    v_pk_add_f32 v[28:29], v[28:29], v[60:61]
    v_pk_add_f32 v[30:31], v[30:31], v[62:63]
    s_waitcnt lgkmcnt(0)
    v_pk_add_f32 v[16:17], v[16:17], v[64:65]
    v_pk_add_f32 v[18:19], v[18:19], v[66:67]
    v_pk_add_f32 v[20:21], v[20:21], v[68:69]
    v_pk_add_f32 v[22:23], v[22:23], v[70:71]
    v_pk_add_f32 v[24:25], v[24:25], v[72:73]
    v_pk_add_f32 v[26:27], v[26:27], v[74:75]
    v_pk_add_f32 v[28:29], v[28:29], v[76:77]
    v_pk_add_f32 v[30:31], v[30:31], v[78:79]
    v_cvt_pk_bf16_f32 v32, v16, v17
    v_cvt_pk_bf16_f32 v33, v18, v19
    v_cvt_pk_bf16_f32 v34, v20, v21
    v_cvt_pk_bf16_f32 v35, v22, v23
    v_cvt_pk_bf16_f32 v36, v24, v25
    v_cvt_pk_bf16_f32 v37, v26, v27
    v_cvt_pk_bf16_f32 v38, v28, v29
    v_cvt_pk_bf16_f32 v39, v30, v31
    buffer_store_dwordx4 v[32:35], v15, s[64:67], s23 offen
    buffer_store_dwordx4 v[36:39], v15, s[64:67], s23 offen offset:32
L_exit:
    s_endpgm
L_code_end:
.section .rodata,"a"
.p2align 6
.amdhsa_kernel gated_mix__mha_block__mixer_token_mlp__prompt_kernel
  .amdhsa_next_free_vgpr 256
  .amdhsa_next_free_sgpr 102
  .amdhsa_accum_offset 256
  .amdhsa_group_segment_fixed_size 0
  .amdhsa_kernarg_size 96
  .amdhsa_user_sgpr_count 2
  .amdhsa_user_sgpr_kernarg_segment_ptr 1
  .amdhsa_system_sgpr_workgroup_id_x 1
.end_amdhsa_kernel
```
